```python
import torch

def _softmax(x, axis=-1):
    return torch.softmax(x, dim=axis)
def _gelu(x):
    return torch.nn.functional.gelu(x, approximate="tanh")
def _silu(x):
    return torch.nn.functional.silu(x)
def _sigmoid(x):
    return torch.sigmoid(x)
def _layernorm(x, axis=-1, eps=1e-5):
    m = x.mean(dim=axis, keepdim=True)
    v = x.var(dim=axis, keepdim=True, unbiased=False)
    return (x - m) / torch.sqrt(v + eps)
def _scatter_add(tgt, idx, src, axis=0):
    return tgt.clone().index_add_(axis, idx, src)
def _segment_sum(src, seg, n):
    out = torch.zeros((n,) + src.shape[1:], dtype=src.dtype)
    return out.index_add_(0, seg, src)
def _pad(x, pw):
    flat = tuple(v for pair in reversed(pw) for v in pair)
    return torch.nn.functional.pad(x, flat)

kernel_name = 'standalone__controlnet__diffusion'

def setup_inputs():

    _w = (lambda a: (lambda t: t.to(torch.bfloat16) if t.is_floating_point() else t)(torch.as_tensor(a)))
    B, HW, C = 2, 32, 512
    sc = C ** -0.5
    return {
        "x_frozen": _w((lambda *s: torch.randn(*s, dtype=torch.bfloat16) * 0.4)(B, HW, HW, C)),
        "x": _w((lambda *s: torch.randn(*s, dtype=torch.bfloat16) * 0.8)(B, HW, HW, C)),
        "c": _w((lambda *s: torch.randn(*s, dtype=torch.bfloat16) * 1.6)(B, HW, HW, C)),
        "w_z1": _w((lambda *s: torch.randn(*s, dtype=torch.bfloat16) * 1.6)(C, C) * sc),
        "w_z2": _w((lambda *s: torch.randn(*s, dtype=torch.bfloat16) * 0.8)(C, C) * sc),
        "w_conv": _w((lambda *s: torch.randn(*s, dtype=torch.bfloat16) * 0.8)(3, 3, C, C) * sc / 3.0),
    }

def reference(x_frozen, x, c, w_z1, w_z2, w_conv):
    B, H, W, C = x.shape
    h_in = x + torch.einsum("bhwc,cd->bhwd", c, w_z1)
    h = _silu(_layernorm(h_in, axis=-1))
    hp = _pad(h, ((0, 0), (1, 1), (1, 1), (0, 0)))
    acc = h * 0.0
    for di in range(3):
        for dj in range(3):
            acc = acc + torch.einsum("bhwc,cd->bhwd", hp[:, di:di + H, dj:dj + W, :], w_conv[di, dj])
    h = h_in + acc
    return x_frozen + torch.einsum("bhwc,cd->bhwd", h, w_z2)
```

```asm
; @launch grid=(256,1,1) block=(384,1,1) lds=147712
.amdgcn_target "amdgcn-amd-amdhsa--gfx950"
.text
.globl standalone__controlnet__diffusion_kernel
.p2align 8
.type standalone__controlnet__diffusion_kernel,@function
standalone__controlnet__diffusion_kernel:
  s_cmp_ge_u32 s2, 256
  s_cbranch_scc1 K1_end
  s_load_dwordx4 s[4:7], s[0:1], 8
  s_load_dwordx4 s[8:11], s[0:1], 24
  s_load_dwordx2 s[12:13], s[0:1], 40
  s_load_dwordx4 s[16:19], s[0:1], 56

  v_lshrrev_b32 v1, 6, v0
  v_and_b32 v0, 63, v0
  s_and_b32 s24, s2, 7
  v_readfirstlane_b32 s3, v1
  s_lshr_b32 s25, s2, 3

  s_and_b32 s31, s25, 7
  s_lshr_b32 s33, s3, 2
  s_or_b32 s31, s31, s33
  s_cmp_lg_u32 s31, 0
  s_cbranch_scc1 K1_nocpf
  s_getpc_b64 s[44:45]

K1_pc:
  s_sub_u32 s44, s44, K1_pc-standalone__controlnet__diffusion_kernel
  s_subb_u32 s45, s45, 0
  v_lshlrev_b32 v1, 7, v0
  s_lshl_b32 s31, s3, 13
  v_add_u32 v1, s31, v1
  v_min_u32 v1, CODE_END-standalone__controlnet__diffusion_kernel-4, v1
  global_load_dword v1, v1, s[44:45]

K1_nocpf:
  v_lshlrev_b32 v2, 4, v0
  v_lshrrev_b32 v10, 3, v0
  v_and_b32 v11, 7, v0
  v_lshrrev_b32 v12, 4, v0
  v_xor_b32 v13, v11, v12
  v_lshlrev_b32 v3, 10, v10
  v_lshl_add_u32 v3, v13, 4, v3
  v_xor_b32 v4, 64, v3
  v_bfe_u32 v14, v0, 2, 2
  v_and_b32 v15, 3, v0
  v_and_b32 v16, 1, v12
  v_lshrrev_b32 v17, 5, v0
  v_and_b32 v18, 31, v0

  v_and_b32 v199, 15, v0
  v_lshlrev_b32 v199, 4, v199
  v_lshl_add_u32 v199, v17, 8, v199
  v_lshl_add_u32 v199, v16, 10, v199

  s_cmp_ge_u32 s25, 16
  s_cbranch_scc1 K1_FZ

  s_lshl_b32 s26, s24, 1
  s_lshr_b32 s27, s25, 3
  s_add_u32 s26, s26, s27
  s_and_b32 s27, s25, 7
  s_cmp_lt_u32 s3, 4
  s_cbranch_scc1 K1G_comp

  s_setprio 3
  s_sub_u32 s28, s3, 4
  s_lshl_b32 s40, s26, 17
  s_lshl_b32 s31, s28, 16
  s_add_u32 s40, s40, s31
  s_lshl_b32 s41, s28, 13
  v_lshrrev_b32 v19, 2, v11
  v_xor_b32 v19, v19, v16
  v_lshlrev_b32 v6, 10, v10
  v_lshl_add_u32 v6, v19, 6, v6
  v_lshl_add_u32 v6, v15, 4, v6
  s_lshl_b32 s44, s28, 15
  s_lshl_b32 s31, s27, 7
  s_add_u32 s44, s44, s31
  s_add_u32 s47, s40, s31
  s_lshl_b32 s45, s28, 12
  s_add_u32 s45, s45, 81920
  s_and_b32 s46, s26, 1
  s_lshl_b32 s46, s46, 2
  s_add_u32 s46, s46, s27
  s_waitcnt lgkmcnt(0)

  s_mov_b32 s48, s8
  s_mov_b32 s49, s9
  s_mov_b32 s50, 0x80000
  s_mov_b32 s51, 0x20000
  s_mov_b32 s52, s6
  s_mov_b32 s53, s7
  s_mov_b32 s54, 0x200000
  s_mov_b32 s55, 0x20000
  s_add_u32 s42, s46, 0
  s_and_b32 s42, s42, 7
  s_lshl_b32 s43, s42, 16
  s_lshl_b32 s42, s42, 7
  s_add_u32 s43, s43, s44
  s_add_u32 s42, s42, s40
  s_add_u32 m0, s45, 0
  s_add_u32 s31, s43, 0
  buffer_load_dwordx4 v6, s[48:51], s31 offen lds
  s_add_u32 m0, s41, 0
  s_add_u32 s31, s42, 0
  buffer_load_dwordx4 v3, s[52:55], s31 offen lds
  s_add_u32 m0, s41, 1024
  s_add_u32 s31, s42, 8192
  buffer_load_dwordx4 v4, s[52:55], s31 offen lds
  s_add_u32 m0, s45, 1024
  s_add_u32 s31, s43, 8192
  buffer_load_dwordx4 v6, s[48:51], s31 offen lds
  s_add_u32 m0, s41, 2048
  s_add_u32 s31, s42, 16384
  buffer_load_dwordx4 v3, s[52:55], s31 offen lds
  s_add_u32 m0, s41, 3072
  s_add_u32 s31, s42, 24576
  buffer_load_dwordx4 v4, s[52:55], s31 offen lds
  s_add_u32 m0, s45, 2048
  s_add_u32 s31, s43, 16384
  buffer_load_dwordx4 v6, s[48:51], s31 offen lds
  s_add_u32 m0, s41, 4096
  s_add_u32 s31, s42, 32768
  buffer_load_dwordx4 v3, s[52:55], s31 offen lds
  s_add_u32 m0, s41, 5120
  s_add_u32 s31, s42, 40960
  buffer_load_dwordx4 v4, s[52:55], s31 offen lds
  s_add_u32 m0, s45, 3072
  s_add_u32 s31, s43, 24576
  buffer_load_dwordx4 v6, s[48:51], s31 offen lds
  s_add_u32 m0, s41, 6144
  s_add_u32 s31, s42, 49152
  buffer_load_dwordx4 v3, s[52:55], s31 offen lds
  s_add_u32 m0, s41, 7168
  s_add_u32 s31, s42, 57344
  buffer_load_dwordx4 v4, s[52:55], s31 offen lds
  s_mov_b32 s56, s18
  s_mov_b32 s57, s19
  s_mov_b32 s58, 0x1000000
  s_mov_b32 s59, 0x20000
  s_mov_b32 s60, s4
  s_mov_b32 s61, s5
  s_mov_b32 s62, 0x200000
  s_mov_b32 s63, 0x20000
  s_lshl_b32 s36, s26, 2
  s_lshl_b32 s31, s28, 1
  s_add_u32 s36, s36, s31
  s_lshl_b32 s36, s36, 12
  s_add_u32 s69, s36, 0xd00000
  s_add_u32 s36, s36, 0xc00000
  v_lshlrev_b32 v5, 7, v0

  s_add_u32 s42, s46, 1
  s_and_b32 s42, s42, 7
  s_lshl_b32 s43, s42, 16
  s_lshl_b32 s42, s42, 7
  s_add_u32 s43, s43, s44
  s_add_u32 s42, s42, s40
  s_add_u32 m0, s45, 8192
  s_add_u32 s31, s43, 0
  buffer_load_dwordx4 v6, s[48:51], s31 offen lds
  s_add_u32 m0, s41, 16384
  s_add_u32 s31, s42, 0
  buffer_load_dwordx4 v3, s[52:55], s31 offen lds
  s_add_u32 m0, s41, 17408
  s_add_u32 s31, s42, 8192
  buffer_load_dwordx4 v4, s[52:55], s31 offen lds
  s_add_u32 m0, s45, 9216
  s_add_u32 s31, s43, 8192
  buffer_load_dwordx4 v6, s[48:51], s31 offen lds
  s_add_u32 m0, s41, 18432
  s_add_u32 s31, s42, 16384
  buffer_load_dwordx4 v3, s[52:55], s31 offen lds
  s_add_u32 m0, s41, 19456
  s_add_u32 s31, s42, 24576
  buffer_load_dwordx4 v4, s[52:55], s31 offen lds
  s_add_u32 m0, s45, 10240
  s_add_u32 s31, s43, 16384
  buffer_load_dwordx4 v6, s[48:51], s31 offen lds
  s_add_u32 m0, s41, 20480
  s_add_u32 s31, s42, 32768
  buffer_load_dwordx4 v3, s[52:55], s31 offen lds
  s_add_u32 m0, s41, 21504
  s_add_u32 s31, s42, 40960
  buffer_load_dwordx4 v4, s[52:55], s31 offen lds
  s_add_u32 m0, s45, 11264
  s_add_u32 s31, s43, 24576
  buffer_load_dwordx4 v6, s[48:51], s31 offen lds
  s_add_u32 m0, s41, 22528
  s_add_u32 s31, s42, 49152
  buffer_load_dwordx4 v3, s[52:55], s31 offen lds
  s_add_u32 m0, s41, 23552
  s_add_u32 s31, s42, 57344
  buffer_load_dwordx4 v4, s[52:55], s31 offen lds
  s_add_u32 s42, s46, 2
  s_and_b32 s42, s42, 7
  s_lshl_b32 s43, s42, 16
  s_lshl_b32 s42, s42, 7
  s_add_u32 s43, s43, s44
  s_add_u32 s42, s42, s40
  s_add_u32 m0, s45, 16384
  s_add_u32 s31, s43, 0
  buffer_load_dwordx4 v6, s[48:51], s31 offen lds
  s_add_u32 m0, s41, 32768
  s_add_u32 s31, s42, 0
  buffer_load_dwordx4 v3, s[52:55], s31 offen lds
  s_add_u32 m0, s41, 33792
  s_add_u32 s31, s42, 8192
  buffer_load_dwordx4 v4, s[52:55], s31 offen lds
  s_add_u32 m0, s45, 17408
  s_add_u32 s31, s43, 8192
  buffer_load_dwordx4 v6, s[48:51], s31 offen lds
  s_add_u32 m0, s41, 34816
  s_add_u32 s31, s42, 16384
  buffer_load_dwordx4 v3, s[52:55], s31 offen lds
  s_add_u32 m0, s41, 35840
  s_add_u32 s31, s42, 24576
  buffer_load_dwordx4 v4, s[52:55], s31 offen lds
  s_add_u32 m0, s45, 18432
  s_add_u32 s31, s43, 16384
  buffer_load_dwordx4 v6, s[48:51], s31 offen lds
  s_add_u32 m0, s41, 36864
  s_add_u32 s31, s42, 32768
  buffer_load_dwordx4 v3, s[52:55], s31 offen lds
  s_add_u32 m0, s41, 37888
  s_add_u32 s31, s42, 40960
  buffer_load_dwordx4 v4, s[52:55], s31 offen lds
  s_add_u32 m0, s45, 19456
  s_add_u32 s31, s43, 24576
  buffer_load_dwordx4 v6, s[48:51], s31 offen lds
  s_add_u32 m0, s41, 38912
  s_add_u32 s31, s42, 49152
  buffer_load_dwordx4 v3, s[52:55], s31 offen lds
  s_add_u32 m0, s41, 39936
  s_add_u32 s31, s42, 57344
  buffer_load_dwordx4 v4, s[52:55], s31 offen lds
  s_waitcnt vmcnt(24)
  s_barrier
  s_add_u32 s42, s46, 3
  s_and_b32 s42, s42, 7
  s_lshl_b32 s43, s42, 16
  s_lshl_b32 s42, s42, 7
  s_add_u32 s43, s43, s44
  s_add_u32 s42, s42, s40
  s_add_u32 m0, s45, 24576
  s_add_u32 s31, s43, 0
  buffer_load_dwordx4 v6, s[48:51], s31 offen lds
  s_add_u32 m0, s41, 49152
  s_add_u32 s31, s42, 0
  buffer_load_dwordx4 v3, s[52:55], s31 offen lds
  s_add_u32 m0, s41, 50176
  s_add_u32 s31, s42, 8192
  buffer_load_dwordx4 v4, s[52:55], s31 offen lds
  s_add_u32 m0, s45, 25600
  s_add_u32 s31, s43, 8192
  buffer_load_dwordx4 v6, s[48:51], s31 offen lds
  s_add_u32 m0, s41, 51200
  s_add_u32 s31, s42, 16384
  buffer_load_dwordx4 v3, s[52:55], s31 offen lds
  s_add_u32 m0, s41, 52224
  s_add_u32 s31, s42, 24576
  buffer_load_dwordx4 v4, s[52:55], s31 offen lds
  s_add_u32 m0, s45, 26624
  s_add_u32 s31, s43, 16384
  buffer_load_dwordx4 v6, s[48:51], s31 offen lds
  s_add_u32 m0, s41, 53248
  s_add_u32 s31, s42, 32768
  buffer_load_dwordx4 v3, s[52:55], s31 offen lds
  s_add_u32 m0, s41, 54272
  s_add_u32 s31, s42, 40960
  buffer_load_dwordx4 v4, s[52:55], s31 offen lds
  s_add_u32 m0, s45, 27648
  s_add_u32 s31, s43, 24576
  buffer_load_dwordx4 v6, s[48:51], s31 offen lds
  s_add_u32 m0, s41, 55296
  s_add_u32 s31, s42, 49152
  buffer_load_dwordx4 v3, s[52:55], s31 offen lds
  s_add_u32 m0, s41, 56320
  s_add_u32 s31, s42, 57344
  buffer_load_dwordx4 v4, s[52:55], s31 offen lds
  s_waitcnt vmcnt(24)
  s_barrier
  s_add_u32 s42, s46, 4
  s_and_b32 s42, s42, 7
  s_lshl_b32 s43, s42, 16
  s_lshl_b32 s42, s42, 7
  s_add_u32 s43, s43, s44
  s_add_u32 s42, s42, s40
  s_add_u32 m0, s45, 32768
  s_add_u32 s31, s43, 0
  buffer_load_dwordx4 v6, s[48:51], s31 offen lds
  s_add_u32 m0, s41, 65536
  s_add_u32 s31, s42, 0
  buffer_load_dwordx4 v3, s[52:55], s31 offen lds
  s_add_u32 m0, s41, 66560
  s_add_u32 s31, s42, 8192
  buffer_load_dwordx4 v4, s[52:55], s31 offen lds
  s_add_u32 m0, s45, 33792
  s_add_u32 s31, s43, 8192
  buffer_load_dwordx4 v6, s[48:51], s31 offen lds
  s_add_u32 m0, s41, 67584
  s_add_u32 s31, s42, 16384
  buffer_load_dwordx4 v3, s[52:55], s31 offen lds
  s_add_u32 m0, s41, 68608
  s_add_u32 s31, s42, 24576
  buffer_load_dwordx4 v4, s[52:55], s31 offen lds
  s_add_u32 m0, s45, 34816
  s_add_u32 s31, s43, 16384
  buffer_load_dwordx4 v6, s[48:51], s31 offen lds
  s_add_u32 m0, s41, 69632
  s_add_u32 s31, s42, 32768
  buffer_load_dwordx4 v3, s[52:55], s31 offen lds
  s_add_u32 m0, s41, 70656
  s_add_u32 s31, s42, 40960
  buffer_load_dwordx4 v4, s[52:55], s31 offen lds
  s_add_u32 m0, s45, 35840
  s_add_u32 s31, s43, 24576
  buffer_load_dwordx4 v6, s[48:51], s31 offen lds
  s_add_u32 m0, s41, 71680
  s_add_u32 s31, s42, 49152
  buffer_load_dwordx4 v3, s[52:55], s31 offen lds
  s_add_u32 m0, s41, 72704
  s_add_u32 s31, s42, 57344
  buffer_load_dwordx4 v4, s[52:55], s31 offen lds
  s_waitcnt vmcnt(24)
  s_barrier
  s_add_u32 s42, s46, 5
  s_and_b32 s42, s42, 7
  s_lshl_b32 s43, s42, 16
  s_lshl_b32 s42, s42, 7
  s_add_u32 s43, s43, s44
  s_add_u32 s42, s42, s40
  s_add_u32 m0, s45, 0
  s_add_u32 s31, s43, 0
  buffer_load_dwordx4 v6, s[48:51], s31 offen lds
  s_add_u32 m0, s41, 0
  s_add_u32 s31, s42, 0
  buffer_load_dwordx4 v3, s[52:55], s31 offen lds
  s_add_u32 m0, s41, 1024
  s_add_u32 s31, s42, 8192
  buffer_load_dwordx4 v4, s[52:55], s31 offen lds
  s_add_u32 m0, s45, 1024
  s_add_u32 s31, s43, 8192
  buffer_load_dwordx4 v6, s[48:51], s31 offen lds
  s_add_u32 m0, s41, 2048
  s_add_u32 s31, s42, 16384
  buffer_load_dwordx4 v3, s[52:55], s31 offen lds
  s_add_u32 m0, s41, 3072
  s_add_u32 s31, s42, 24576
  buffer_load_dwordx4 v4, s[52:55], s31 offen lds
  s_add_u32 m0, s45, 2048
  s_add_u32 s31, s43, 16384
  buffer_load_dwordx4 v6, s[48:51], s31 offen lds
  s_add_u32 m0, s41, 4096
  s_add_u32 s31, s42, 32768
  buffer_load_dwordx4 v3, s[52:55], s31 offen lds
  s_add_u32 m0, s41, 5120
  s_add_u32 s31, s42, 40960
  buffer_load_dwordx4 v4, s[52:55], s31 offen lds
  s_add_u32 m0, s45, 3072
  s_add_u32 s31, s43, 24576
  buffer_load_dwordx4 v6, s[48:51], s31 offen lds
  s_add_u32 m0, s41, 6144
  s_add_u32 s31, s42, 49152
  buffer_load_dwordx4 v3, s[52:55], s31 offen lds
  s_add_u32 m0, s41, 7168
  s_add_u32 s31, s42, 57344
  buffer_load_dwordx4 v4, s[52:55], s31 offen lds
  s_waitcnt vmcnt(24)
  s_barrier
  s_add_u32 s42, s46, 6
  s_and_b32 s42, s42, 7
  s_lshl_b32 s43, s42, 16
  s_lshl_b32 s42, s42, 7
  s_add_u32 s43, s43, s44
  s_add_u32 s42, s42, s40
  s_add_u32 m0, s45, 8192
  s_add_u32 s31, s43, 0
  buffer_load_dwordx4 v6, s[48:51], s31 offen lds
  s_add_u32 m0, s41, 16384
  s_add_u32 s31, s42, 0
  buffer_load_dwordx4 v3, s[52:55], s31 offen lds
  s_add_u32 m0, s41, 17408
  s_add_u32 s31, s42, 8192
  buffer_load_dwordx4 v4, s[52:55], s31 offen lds
  s_add_u32 m0, s45, 9216
  s_add_u32 s31, s43, 8192
  buffer_load_dwordx4 v6, s[48:51], s31 offen lds
  s_add_u32 m0, s41, 18432
  s_add_u32 s31, s42, 16384
  buffer_load_dwordx4 v3, s[52:55], s31 offen lds
  s_add_u32 m0, s41, 19456
  s_add_u32 s31, s42, 24576
  buffer_load_dwordx4 v4, s[52:55], s31 offen lds
  s_add_u32 m0, s45, 10240
  s_add_u32 s31, s43, 16384
  buffer_load_dwordx4 v6, s[48:51], s31 offen lds
  s_add_u32 m0, s41, 20480
  s_add_u32 s31, s42, 32768
  buffer_load_dwordx4 v3, s[52:55], s31 offen lds
  s_add_u32 m0, s41, 21504
  s_add_u32 s31, s42, 40960
  buffer_load_dwordx4 v4, s[52:55], s31 offen lds
  s_add_u32 m0, s45, 11264
  s_add_u32 s31, s43, 24576
  buffer_load_dwordx4 v6, s[48:51], s31 offen lds
  s_add_u32 m0, s41, 22528
  s_add_u32 s31, s42, 49152
  buffer_load_dwordx4 v3, s[52:55], s31 offen lds
  s_add_u32 m0, s41, 23552
  s_add_u32 s31, s42, 57344
  buffer_load_dwordx4 v4, s[52:55], s31 offen lds
  s_add_u32 m0, s41, 122880
  s_add_u32 s31, s47, 0
  buffer_load_dwordx4 v3, s[60:63], s31 offen lds
  s_add_u32 m0, s41, 123904
  s_add_u32 s31, s47, 8192
  buffer_load_dwordx4 v4, s[60:63], s31 offen lds
  s_add_u32 m0, s41, 124928
  s_add_u32 s31, s47, 16384
  buffer_load_dwordx4 v3, s[60:63], s31 offen lds
  s_add_u32 m0, s41, 125952
  s_add_u32 s31, s47, 24576
  buffer_load_dwordx4 v4, s[60:63], s31 offen lds
  s_add_u32 m0, s41, 126976
  s_add_u32 s31, s47, 32768
  buffer_load_dwordx4 v3, s[60:63], s31 offen lds
  s_add_u32 m0, s41, 128000
  s_add_u32 s31, s47, 40960
  buffer_load_dwordx4 v4, s[60:63], s31 offen lds
  s_add_u32 m0, s41, 129024
  s_add_u32 s31, s47, 49152
  buffer_load_dwordx4 v3, s[60:63], s31 offen lds
  s_add_u32 m0, s41, 130048
  s_add_u32 s31, s47, 57344
  buffer_load_dwordx4 v4, s[60:63], s31 offen lds
  s_waitcnt vmcnt(32)
  s_barrier
  s_add_u32 s42, s46, 7
  s_and_b32 s42, s42, 7
  s_lshl_b32 s43, s42, 16
  s_lshl_b32 s42, s42, 7
  s_add_u32 s43, s43, s44
  s_add_u32 s42, s42, s40
  s_add_u32 m0, s45, 16384
  s_add_u32 s31, s43, 0
  buffer_load_dwordx4 v6, s[48:51], s31 offen lds
  s_add_u32 m0, s41, 32768
  s_add_u32 s31, s42, 0
  buffer_load_dwordx4 v3, s[52:55], s31 offen lds
  s_add_u32 m0, s41, 33792
  s_add_u32 s31, s42, 8192
  buffer_load_dwordx4 v4, s[52:55], s31 offen lds
  s_add_u32 m0, s45, 17408
  s_add_u32 s31, s43, 8192
  buffer_load_dwordx4 v6, s[48:51], s31 offen lds
  s_add_u32 m0, s41, 34816
  s_add_u32 s31, s42, 16384
  buffer_load_dwordx4 v3, s[52:55], s31 offen lds
  s_add_u32 m0, s41, 35840
  s_add_u32 s31, s42, 24576
  buffer_load_dwordx4 v4, s[52:55], s31 offen lds
  s_add_u32 m0, s45, 18432
  s_add_u32 s31, s43, 16384
  buffer_load_dwordx4 v6, s[48:51], s31 offen lds
  s_add_u32 m0, s41, 36864
  s_add_u32 s31, s42, 32768
  buffer_load_dwordx4 v3, s[52:55], s31 offen lds
  s_add_u32 m0, s41, 37888
  s_add_u32 s31, s42, 40960
  buffer_load_dwordx4 v4, s[52:55], s31 offen lds
  s_add_u32 m0, s45, 19456
  s_add_u32 s31, s43, 24576
  buffer_load_dwordx4 v6, s[48:51], s31 offen lds
  s_add_u32 m0, s41, 38912
  s_add_u32 s31, s42, 49152
  buffer_load_dwordx4 v3, s[52:55], s31 offen lds
  s_add_u32 m0, s41, 39936
  s_add_u32 s31, s42, 57344
  buffer_load_dwordx4 v4, s[52:55], s31 offen lds
  s_waitcnt vmcnt(32)
  s_barrier
  s_waitcnt vmcnt(20)
  s_barrier
  s_waitcnt vmcnt(0)
  s_barrier
  s_mov_b32 s38, 0
  v_mov_b32 v8, 139264
  ds_read_b64 v[26:27], v8
  s_waitcnt lgkmcnt(0)
  s_barrier
K1G_poll:
  s_cmp_ge_u32 s38, 40
  s_cbranch_scc1 K1G_pollB
  buffer_load_dwordx4 v[32:35], v2, s[56:59], s36 offen offset:0 sc1
  buffer_load_dwordx4 v[36:39], v2, s[56:59], s36 offen offset:1024 sc1
  buffer_load_dwordx4 v[40:43], v2, s[56:59], s36 offen offset:2048 sc1
  buffer_load_dwordx4 v[44:47], v2, s[56:59], s36 offen offset:3072 sc1
  v_add_u32 v7, 0x1000, v2
  buffer_load_dwordx4 v[48:51], v7, s[56:59], s36 offen sc1
  buffer_load_dwordx4 v[52:55], v7, s[56:59], s36 offen offset:1024 sc1
  buffer_load_dwordx4 v[56:59], v7, s[56:59], s36 offen offset:2048 sc1
  buffer_load_dwordx4 v[60:63], v7, s[56:59], s36 offen offset:3072 sc1
  s_branch K1G_pchk
K1G_pollB:
  s_sleep 1
  v_add_u32 v7, 0x1000, v2
  buffer_load_dwordx4 v[32:35], v2, s[56:59], s69 offen offset:0 sc1
  buffer_load_dwordx4 v[36:39], v2, s[56:59], s69 offen offset:1024 sc1
  buffer_load_dwordx4 v[40:43], v2, s[56:59], s69 offen offset:2048 sc1
  buffer_load_dwordx4 v[44:47], v2, s[56:59], s69 offen offset:3072 sc1
  buffer_load_dwordx4 v[48:51], v7, s[56:59], s69 offen offset:0 sc1
  buffer_load_dwordx4 v[52:55], v7, s[56:59], s69 offen offset:1024 sc1
  buffer_load_dwordx4 v[56:59], v7, s[56:59], s69 offen offset:2048 sc1
  buffer_load_dwordx4 v[60:63], v7, s[56:59], s69 offen offset:3072 sc1
K1G_pchk:
  s_waitcnt vmcnt(0)
  v_xor_b32 v64, v34, v26
  v_xor_b32 v65, v35, v27
  v_xor_b32 v66, v38, v26
  v_xor_b32 v67, v39, v27
  v_xor_b32 v68, v42, v26
  v_xor_b32 v69, v43, v27
  v_xor_b32 v70, v46, v26
  v_xor_b32 v71, v47, v27
  v_xor_b32 v72, v50, v26
  v_xor_b32 v73, v51, v27
  v_xor_b32 v74, v54, v26
  v_xor_b32 v75, v55, v27
  v_xor_b32 v76, v58, v26
  v_xor_b32 v77, v59, v27
  v_xor_b32 v78, v62, v26
  v_xor_b32 v79, v63, v27
  v_or3_b32 v64, v64, v65, v66
  v_or3_b32 v67, v67, v68, v69
  v_or3_b32 v70, v70, v71, v72
  v_or3_b32 v73, v73, v74, v75
  v_or3_b32 v76, v76, v77, v78
  v_or3_b32 v64, v64, v67, v70
  v_or3_b32 v73, v73, v76, v79
  v_or_b32 v64, v64, v73
  v_cmp_ne_u32 vcc, 0, v64
  s_nop 3
  s_cmp_eq_u64 vcc, 0
  s_cbranch_scc1 K1G_got
  s_add_u32 s38, s38, 1
  s_cmp_lt_u32 s38, 0x40000
  s_cbranch_scc1 K1G_poll

K1G_got:
  s_mov_b32 s68, 0x3c800000
  s_lshl_b32 s31, s28, 10
  s_add_u32 s31, s31, 139328
  v_lshlrev_b32 v29, 3, v0
  v_add_u32 v29, s31, v29

  v_add_f32 v80, v32, v36
  v_add_f32 v81, v40, v44
  v_add_f32 v82, v33, v37
  v_add_f32 v83, v41, v45
  v_add_f32 v80, v80, v81
  v_add_f32 v82, v82, v83
  v_mov_b32 v81, v80

  v_add_f32 v88, v48, v52
  v_add_f32 v89, v56, v60
  v_add_f32 v90, v49, v53
  v_add_f32 v91, v57, v61
  v_add_f32 v88, v88, v89
  v_add_f32 v90, v90, v91
  v_mov_b32 v89, v88

  s_nop 1
  v_permlane32_swap_b32 v80, v81
  v_permlane32_swap_b32 v88, v89
  s_nop 1
  v_add_f32 v80, v80, v81
  v_mul_f32 v80, 0x3b000000, v80
  v_fma_f32 v84, v32, s68, -v80
  v_fma_f32 v85, v36, s68, -v80
  v_fma_f32 v86, v40, s68, -v80
  v_fma_f32 v87, v44, s68, -v80
  v_mul_f32 v84, v84, v84
  v_fmac_f32 v84, v85, v85
  v_fmac_f32 v84, v86, v86
  v_fmac_f32 v84, v87, v87
  v_fmac_f32 v82, 0x42800000, v84
  v_mov_b32 v83, v82
  v_add_f32 v88, v88, v89
  v_mul_f32 v88, 0x3b000000, v88
  v_fma_f32 v92, v48, s68, -v88
  v_fma_f32 v93, v52, s68, -v88
  v_fma_f32 v94, v56, s68, -v88
  v_fma_f32 v95, v60, s68, -v88
  v_mul_f32 v92, v92, v92
  v_fmac_f32 v92, v93, v93
  v_fmac_f32 v92, v94, v94
  v_fmac_f32 v92, v95, v95
  v_fmac_f32 v90, 0x42800000, v92
  v_mov_b32 v91, v90
  s_nop 1
  v_permlane32_swap_b32 v82, v83
  v_permlane32_swap_b32 v90, v91
  s_nop 1
  v_add_f32 v82, v82, v83
  v_mov_b32 v83, 0x3727c5ac
  v_fmac_f32 v83, 0x3b000000, v82
  v_rsq_f32 v81, v83

  v_add_f32 v90, v90, v91
  v_mov_b32 v91, 0x3727c5ac
  v_fmac_f32 v91, 0x3b000000, v90
  v_rsq_f32 v89, v91

  s_nop 0
  ds_write_b64 v29, v[80:81]
  ds_write_b64 v29, v[88:89] offset:512
  s_waitcnt lgkmcnt(0)
  s_barrier
  s_endpgm

K1G_comp:
  s_lshl_b32 s30, s26, 2
  s_add_u32 s30, s30, s3
  s_memrealtime s[70:71]
  s_and_b32 s46, s26, 1
  s_lshl_b32 s46, s46, 2
  s_add_u32 s46, s46, s27
  s_add_u32 s46, s46, s3
  s_add_u32 s46, s46, 1
  s_and_b32 s46, s46, 7
  s_lshl_b32 s46, s46, 16
  s_lshl_b32 s31, s27, 7
  s_add_u32 s46, s46, s31
  v_lshlrev_b32 v9, 10, v0
  s_waitcnt lgkmcnt(0)

  s_mov_b32 s48, s8
  s_mov_b32 s49, s9
  s_mov_b32 s50, 0x80000
  s_mov_b32 s51, 0x20000
  s_mov_b32 s64, s16
  s_mov_b32 s65, s17
  s_mov_b32 s66, 0x100
  s_mov_b32 s67, 0x20000
  v_mov_b32 v204, 0
  s_or_b32 s31, s2, s3
  s_cmp_lg_u32 s31, 0
  s_cbranch_scc1 K1G_noat
  s_or_b32 s70, s70, 1
  v_mov_b32 v200, s70
  v_mov_b32 v201, s71
  s_mov_b64 exec, 1
  buffer_store_dwordx2 v[200:201], v204, s[64:67], 0 offen sc1
  s_mov_b64 exec, -1

K1G_noat:
  v_bfe_u32 v20, v18, 2, 2
  v_lshlrev_b32 v20, 3, v20
  v_and_b32 v21, 1, v18
  v_lshl_add_u32 v20, v21, 2, v20
  v_lshrrev_b32 v21, 4, v18
  v_lshl_add_u32 v20, v21, 1, v20
  v_bfe_u32 v21, v18, 1, 1
  v_add_u32 v20, v20, v21

  v_bfe_u32 v21, v20, 1, 3
  v_xor_b32 v21, v21, v17
  v_lshlrev_b32 v22, 7, v20
  v_lshl_add_u32 v22, v21, 4, v22
  s_lshl_b32 s31, s3, 12
  v_add_u32 v24, s31, v22
  v_xor_b32 v25, 32, v24
  v_xor_b32 v26, 64, v24
  v_xor_b32 v27, 0x60, v24
  v_add_u32 v28, 0x10000, v24
  v_add_u32 v29, 0x10000, v25
  v_add_u32 v30, 0x10000, v26
  v_add_u32 v31, 0x10000, v27

  v_lshl_add_u32 v23, v17, 3, v14
  v_lshlrev_b32 v23, 7, v23
  v_lshl_add_u32 v23, v16, 5, v23
  v_and_b32 v21, 1, v15
  v_lshl_add_u32 v23, v21, 4, v23
  v_lshrrev_b32 v21, 1, v15
  v_lshl_add_u32 v23, v21, 3, v23
  v_lshrrev_b32 v21, 1, v14
  v_lshl_add_u32 v8, v21, 6, v23
  v_add_u32 v8, 81920, v8
  v_xor_b32 v9, 64, v8

  v_mov_b32 v32, 0
  v_mov_b32 v33, 0
  v_mov_b32 v34, 0
  v_mov_b32 v35, 0
  v_mov_b32 v36, 0
  v_mov_b32 v37, 0
  v_mov_b32 v38, 0
  v_mov_b32 v39, 0
  v_mov_b32 v40, 0
  v_mov_b32 v41, 0
  v_mov_b32 v42, 0
  v_mov_b32 v43, 0
  v_mov_b32 v44, 0
  v_mov_b32 v45, 0
  v_mov_b32 v46, 0
  v_mov_b32 v47, 0
  v_mov_b32 v48, 0
  v_mov_b32 v49, 0
  v_mov_b32 v50, 0
  v_mov_b32 v51, 0
  v_mov_b32 v52, 0
  v_mov_b32 v53, 0
  v_mov_b32 v54, 0
  v_mov_b32 v55, 0
  v_mov_b32 v56, 0
  v_mov_b32 v57, 0
  v_mov_b32 v58, 0
  v_mov_b32 v59, 0
  v_mov_b32 v60, 0
  v_mov_b32 v61, 0
  v_mov_b32 v62, 0
  v_mov_b32 v63, 0
  s_lshl_b32 s31, s27, 7
  s_add_u32 s31, s31, s30
  s_lshl_b32 s31, s31, 11
  s_add_u32 s32, s31, 0x300000
  s_add_u32 s34, s31, 0x1000
  s_lshl_b32 s36, s30, 12
  s_lshl_b32 s31, s27, 9
  s_add_u32 s36, s36, s31
  s_add_u32 s37, s36, 0xd00000
  s_add_u32 s36, s36, 0xc00000
  s_lshl_b32 s31, s3, 9
  s_add_u32 s31, s31, 139328
  v_lshlrev_b32 v5, 3, v0
  v_add_u32 v5, s31, v5
  v_mov_b32 v6, 139264
  s_waitcnt lgkmcnt(0)

  s_mov_b32 s56, s18
  s_mov_b32 s57, s19
  s_mov_b32 s58, 0x1000000
  s_mov_b32 s59, 0x20000
  s_mov_b32 exec_hi, 0
  buffer_store_dwordx4 v[32:35], v2, s[56:59], s36 offen
  s_mov_b32 exec_hi, -1

  s_barrier
  ds_read_b128 v[64:67], v24 offset:0
  ds_read_b64_tr_b16 v[68:69], v8 offset:0
  ds_read_b64_tr_b16 v[70:71], v8 offset:512
  ds_read_b64_tr_b16 v[72:73], v9 offset:0
  ds_read_b64_tr_b16 v[74:75], v9 offset:512
  ds_read_b128 v[76:79], v25 offset:0
  ds_read_b64_tr_b16 v[80:81], v8 offset:2048
  ds_read_b64_tr_b16 v[82:83], v8 offset:2560
  ds_read_b64_tr_b16 v[84:85], v9 offset:2048
  ds_read_b64_tr_b16 v[86:87], v9 offset:2560
  s_waitcnt lgkmcnt(5)
  v_mfma_f32_32x32x16_bf16 v[32:47], v[68:71], v[64:67], v[32:47]
  ds_read_b128 v[88:91], v26 offset:0
  ds_read_b64_tr_b16 v[92:93], v8 offset:4096
  ds_read_b64_tr_b16 v[94:95], v8 offset:4608
  v_mfma_f32_32x32x16_bf16 v[48:63], v[72:75], v[64:67], v[48:63]
  ds_read_b64_tr_b16 v[96:97], v9 offset:4096
  ds_read_b64_tr_b16 v[98:99], v9 offset:4608
  s_waitcnt lgkmcnt(5)
  v_mfma_f32_32x32x16_bf16 v[32:47], v[80:83], v[76:79], v[32:47]
  ds_read_b128 v[64:67], v27 offset:0
  ds_read_b64_tr_b16 v[68:69], v8 offset:6144
  ds_read_b64_tr_b16 v[70:71], v8 offset:6656
  v_mfma_f32_32x32x16_bf16 v[48:63], v[84:87], v[76:79], v[48:63]
  ds_read_b64_tr_b16 v[72:73], v9 offset:6144
  ds_read_b64_tr_b16 v[74:75], v9 offset:6656
  s_waitcnt lgkmcnt(5)
  v_mfma_f32_32x32x16_bf16 v[32:47], v[92:95], v[88:91], v[32:47]
  s_barrier
  ds_read_b128 v[76:79], v24 offset:16384
  ds_read_b64_tr_b16 v[80:81], v8 offset:8192
  ds_read_b64_tr_b16 v[82:83], v8 offset:8704
  v_mfma_f32_32x32x16_bf16 v[48:63], v[96:99], v[88:91], v[48:63]
  ds_read_b64_tr_b16 v[84:85], v9 offset:8192
  ds_read_b64_tr_b16 v[86:87], v9 offset:8704
  s_waitcnt lgkmcnt(5)
  v_mfma_f32_32x32x16_bf16 v[32:47], v[68:71], v[64:67], v[32:47]
  ds_read_b128 v[88:91], v25 offset:16384
  ds_read_b64_tr_b16 v[92:93], v8 offset:10240
  ds_read_b64_tr_b16 v[94:95], v8 offset:10752
  v_mfma_f32_32x32x16_bf16 v[48:63], v[72:75], v[64:67], v[48:63]
  ds_read_b64_tr_b16 v[96:97], v9 offset:10240
  ds_read_b64_tr_b16 v[98:99], v9 offset:10752
  s_waitcnt lgkmcnt(5)
  v_mfma_f32_32x32x16_bf16 v[32:47], v[80:83], v[76:79], v[32:47]
  ds_read_b128 v[64:67], v26 offset:16384
  ds_read_b64_tr_b16 v[68:69], v8 offset:12288
  ds_read_b64_tr_b16 v[70:71], v8 offset:12800
  v_mfma_f32_32x32x16_bf16 v[48:63], v[84:87], v[76:79], v[48:63]
  ds_read_b64_tr_b16 v[72:73], v9 offset:12288
  ds_read_b64_tr_b16 v[74:75], v9 offset:12800
  s_waitcnt lgkmcnt(5)
  v_mfma_f32_32x32x16_bf16 v[32:47], v[92:95], v[88:91], v[32:47]
  ds_read_b128 v[76:79], v27 offset:16384
  ds_read_b64_tr_b16 v[80:81], v8 offset:14336
  ds_read_b64_tr_b16 v[82:83], v8 offset:14848
  v_mfma_f32_32x32x16_bf16 v[48:63], v[96:99], v[88:91], v[48:63]
  ds_read_b64_tr_b16 v[84:85], v9 offset:14336
  ds_read_b64_tr_b16 v[86:87], v9 offset:14848
  s_waitcnt lgkmcnt(5)
  v_mfma_f32_32x32x16_bf16 v[32:47], v[68:71], v[64:67], v[32:47]
  s_barrier
  ds_read_b128 v[88:91], v24 offset:32768
  ds_read_b64_tr_b16 v[92:93], v8 offset:16384
  ds_read_b64_tr_b16 v[94:95], v8 offset:16896
  v_mfma_f32_32x32x16_bf16 v[48:63], v[72:75], v[64:67], v[48:63]
  ds_read_b64_tr_b16 v[96:97], v9 offset:16384
  ds_read_b64_tr_b16 v[98:99], v9 offset:16896
  s_waitcnt lgkmcnt(5)
  v_mfma_f32_32x32x16_bf16 v[32:47], v[80:83], v[76:79], v[32:47]
  ds_read_b128 v[64:67], v25 offset:32768
  ds_read_b64_tr_b16 v[68:69], v8 offset:18432
  ds_read_b64_tr_b16 v[70:71], v8 offset:18944
  v_mfma_f32_32x32x16_bf16 v[48:63], v[84:87], v[76:79], v[48:63]
  ds_read_b64_tr_b16 v[72:73], v9 offset:18432
  ds_read_b64_tr_b16 v[74:75], v9 offset:18944
  s_waitcnt lgkmcnt(5)
  v_mfma_f32_32x32x16_bf16 v[32:47], v[92:95], v[88:91], v[32:47]
  ds_read_b128 v[76:79], v26 offset:32768
  ds_read_b64_tr_b16 v[80:81], v8 offset:20480
  ds_read_b64_tr_b16 v[82:83], v8 offset:20992
  v_mfma_f32_32x32x16_bf16 v[48:63], v[96:99], v[88:91], v[48:63]
  ds_read_b64_tr_b16 v[84:85], v9 offset:20480
  ds_read_b64_tr_b16 v[86:87], v9 offset:20992
  s_waitcnt lgkmcnt(5)
  v_mfma_f32_32x32x16_bf16 v[32:47], v[68:71], v[64:67], v[32:47]
  ds_read_b128 v[88:91], v27 offset:32768
  ds_read_b64_tr_b16 v[92:93], v8 offset:22528
  ds_read_b64_tr_b16 v[94:95], v8 offset:23040
  v_mfma_f32_32x32x16_bf16 v[48:63], v[72:75], v[64:67], v[48:63]
  ds_read_b64_tr_b16 v[96:97], v9 offset:22528
  ds_read_b64_tr_b16 v[98:99], v9 offset:23040
  s_waitcnt lgkmcnt(5)
  v_mfma_f32_32x32x16_bf16 v[32:47], v[80:83], v[76:79], v[32:47]
  s_barrier
  ds_read_b128 v[64:67], v24 offset:49152
  ds_read_b64_tr_b16 v[68:69], v8 offset:24576
  ds_read_b64_tr_b16 v[70:71], v8 offset:25088
  v_mfma_f32_32x32x16_bf16 v[48:63], v[84:87], v[76:79], v[48:63]
  ds_read_b64_tr_b16 v[72:73], v9 offset:24576
  ds_read_b64_tr_b16 v[74:75], v9 offset:25088
  buffer_load_dwordx2 v[200:201], v204, s[64:67], 0 offen
  s_waitcnt lgkmcnt(5)
  v_mfma_f32_32x32x16_bf16 v[32:47], v[92:95], v[88:91], v[32:47]
  ds_read_b128 v[76:79], v25 offset:49152
  ds_read_b64_tr_b16 v[80:81], v8 offset:26624
  ds_read_b64_tr_b16 v[82:83], v8 offset:27136
  v_mfma_f32_32x32x16_bf16 v[48:63], v[96:99], v[88:91], v[48:63]
  ds_read_b64_tr_b16 v[84:85], v9 offset:26624
  ds_read_b64_tr_b16 v[86:87], v9 offset:27136
  s_waitcnt lgkmcnt(5)
  v_mfma_f32_32x32x16_bf16 v[32:47], v[68:71], v[64:67], v[32:47]
  ds_read_b128 v[88:91], v26 offset:49152
  ds_read_b64_tr_b16 v[92:93], v8 offset:28672
  ds_read_b64_tr_b16 v[94:95], v8 offset:29184
  v_mfma_f32_32x32x16_bf16 v[48:63], v[72:75], v[64:67], v[48:63]
  ds_read_b64_tr_b16 v[96:97], v9 offset:28672
  ds_read_b64_tr_b16 v[98:99], v9 offset:29184
  s_waitcnt lgkmcnt(5)
  v_mfma_f32_32x32x16_bf16 v[32:47], v[80:83], v[76:79], v[32:47]
  ds_read_b128 v[64:67], v27 offset:49152
  ds_read_b64_tr_b16 v[68:69], v8 offset:30720
  ds_read_b64_tr_b16 v[70:71], v8 offset:31232
  v_mfma_f32_32x32x16_bf16 v[48:63], v[84:87], v[76:79], v[48:63]
  ds_read_b64_tr_b16 v[72:73], v9 offset:30720
  ds_read_b64_tr_b16 v[74:75], v9 offset:31232
  s_waitcnt lgkmcnt(5)
  v_mfma_f32_32x32x16_bf16 v[32:47], v[92:95], v[88:91], v[32:47]
  s_barrier
  ds_read_b128 v[76:79], v28 offset:0
  ds_read_b64_tr_b16 v[80:81], v8 offset:32768
  ds_read_b64_tr_b16 v[82:83], v8 offset:33280
  v_mfma_f32_32x32x16_bf16 v[48:63], v[96:99], v[88:91], v[48:63]
  ds_read_b64_tr_b16 v[84:85], v9 offset:32768
  ds_read_b64_tr_b16 v[86:87], v9 offset:33280
  s_waitcnt lgkmcnt(5)
  v_mfma_f32_32x32x16_bf16 v[32:47], v[68:71], v[64:67], v[32:47]
  ds_read_b128 v[88:91], v29 offset:0
  ds_read_b64_tr_b16 v[92:93], v8 offset:34816
  ds_read_b64_tr_b16 v[94:95], v8 offset:35328
  v_mfma_f32_32x32x16_bf16 v[48:63], v[72:75], v[64:67], v[48:63]
  ds_read_b64_tr_b16 v[96:97], v9 offset:34816
  ds_read_b64_tr_b16 v[98:99], v9 offset:35328
  s_waitcnt lgkmcnt(5)
  v_mfma_f32_32x32x16_bf16 v[32:47], v[80:83], v[76:79], v[32:47]
  ds_read_b128 v[64:67], v30 offset:0
  ds_read_b64_tr_b16 v[68:69], v8 offset:36864
  ds_read_b64_tr_b16 v[70:71], v8 offset:37376
  v_mfma_f32_32x32x16_bf16 v[48:63], v[84:87], v[76:79], v[48:63]
  ds_read_b64_tr_b16 v[72:73], v9 offset:36864
  ds_read_b64_tr_b16 v[74:75], v9 offset:37376
  s_waitcnt lgkmcnt(5)
  v_mfma_f32_32x32x16_bf16 v[32:47], v[92:95], v[88:91], v[32:47]
  ds_read_b128 v[76:79], v31 offset:0
  ds_read_b64_tr_b16 v[80:81], v8 offset:38912
  ds_read_b64_tr_b16 v[82:83], v8 offset:39424
  v_mfma_f32_32x32x16_bf16 v[48:63], v[96:99], v[88:91], v[48:63]
  ds_read_b64_tr_b16 v[84:85], v9 offset:38912
  ds_read_b64_tr_b16 v[86:87], v9 offset:39424
  s_waitcnt lgkmcnt(5)
  v_mfma_f32_32x32x16_bf16 v[32:47], v[68:71], v[64:67], v[32:47]
  s_barrier
  ds_read_b128 v[88:91], v24 offset:0
  ds_read_b64_tr_b16 v[92:93], v8 offset:0
  ds_read_b64_tr_b16 v[94:95], v8 offset:512
  v_mfma_f32_32x32x16_bf16 v[48:63], v[72:75], v[64:67], v[48:63]
  ds_read_b64_tr_b16 v[96:97], v9 offset:0
  ds_read_b64_tr_b16 v[98:99], v9 offset:512
  s_waitcnt lgkmcnt(5)
  v_mfma_f32_32x32x16_bf16 v[32:47], v[80:83], v[76:79], v[32:47]
  ds_read_b128 v[64:67], v25 offset:0
  ds_read_b64_tr_b16 v[68:69], v8 offset:2048
  ds_read_b64_tr_b16 v[70:71], v8 offset:2560
  v_mfma_f32_32x32x16_bf16 v[48:63], v[84:87], v[76:79], v[48:63]
  ds_read_b64_tr_b16 v[72:73], v9 offset:2048
  ds_read_b64_tr_b16 v[74:75], v9 offset:2560
  s_waitcnt lgkmcnt(5)
  v_mfma_f32_32x32x16_bf16 v[32:47], v[92:95], v[88:91], v[32:47]
  ds_read_b128 v[76:79], v26 offset:0
  ds_read_b64_tr_b16 v[80:81], v8 offset:4096
  ds_read_b64_tr_b16 v[82:83], v8 offset:4608
  v_mfma_f32_32x32x16_bf16 v[48:63], v[96:99], v[88:91], v[48:63]
  ds_read_b64_tr_b16 v[84:85], v9 offset:4096
  ds_read_b64_tr_b16 v[86:87], v9 offset:4608
  s_waitcnt lgkmcnt(5)
  v_mfma_f32_32x32x16_bf16 v[32:47], v[68:71], v[64:67], v[32:47]
  ds_read_b128 v[88:91], v27 offset:0
  ds_read_b64_tr_b16 v[92:93], v8 offset:6144
  ds_read_b64_tr_b16 v[94:95], v8 offset:6656
  v_mfma_f32_32x32x16_bf16 v[48:63], v[72:75], v[64:67], v[48:63]
  ds_read_b64_tr_b16 v[96:97], v9 offset:6144
  ds_read_b64_tr_b16 v[98:99], v9 offset:6656
  s_waitcnt lgkmcnt(5)
  v_mfma_f32_32x32x16_bf16 v[32:47], v[80:83], v[76:79], v[32:47]
  s_barrier
  ds_read_b128 v[64:67], v24 offset:16384
  ds_read_b64_tr_b16 v[68:69], v8 offset:8192
  ds_read_b64_tr_b16 v[70:71], v8 offset:8704
  v_mfma_f32_32x32x16_bf16 v[48:63], v[84:87], v[76:79], v[48:63]
  ds_read_b64_tr_b16 v[72:73], v9 offset:8192
  ds_read_b64_tr_b16 v[74:75], v9 offset:8704
  s_mov_b32 s33, 0
K1_res1:
  s_waitcnt vmcnt(0)
  v_readfirstlane_b32 s31, v200
  s_add_u32 s33, s33, 1
  s_nop 2
  s_cmp_lg_u32 s31, 0
  s_cbranch_scc1 K1_res1_ok
  s_cmp_ge_u32 s33, 0x40000
  s_cbranch_scc1 K1_res1_ok
  s_sleep 2

  buffer_load_dwordx2 v[200:201], v204, s[64:67], 0 offen sc1
  s_branch K1_res1
K1_res1_ok:
  s_mov_b64 exec, 1
  ds_write_b64 v6, v[200:201]
  s_mov_b64 exec, -1

  s_waitcnt lgkmcnt(5)
  v_mfma_f32_32x32x16_bf16 v[32:47], v[92:95], v[88:91], v[32:47]
  ds_read_b128 v[76:79], v25 offset:16384
  ds_read_b64_tr_b16 v[80:81], v8 offset:10240
  ds_read_b64_tr_b16 v[82:83], v8 offset:10752
  v_mfma_f32_32x32x16_bf16 v[48:63], v[96:99], v[88:91], v[48:63]
  ds_read_b64_tr_b16 v[84:85], v9 offset:10240
  ds_read_b64_tr_b16 v[86:87], v9 offset:10752
  s_waitcnt lgkmcnt(5)
  v_mfma_f32_32x32x16_bf16 v[32:47], v[68:71], v[64:67], v[32:47]
  ds_read_b128 v[88:91], v26 offset:16384
  ds_read_b64_tr_b16 v[92:93], v8 offset:12288
  ds_read_b64_tr_b16 v[94:95], v8 offset:12800
  v_mfma_f32_32x32x16_bf16 v[48:63], v[72:75], v[64:67], v[48:63]
  ds_read_b64_tr_b16 v[96:97], v9 offset:12288
  ds_read_b64_tr_b16 v[98:99], v9 offset:12800
  s_waitcnt lgkmcnt(5)
  v_mfma_f32_32x32x16_bf16 v[32:47], v[80:83], v[76:79], v[32:47]
  ds_read_b128 v[64:67], v27 offset:16384
  ds_read_b64_tr_b16 v[68:69], v8 offset:14336
  ds_read_b64_tr_b16 v[70:71], v8 offset:14848
  v_mfma_f32_32x32x16_bf16 v[48:63], v[84:87], v[76:79], v[48:63]
  ds_read_b64_tr_b16 v[72:73], v9 offset:14336
  ds_read_b64_tr_b16 v[74:75], v9 offset:14848
  s_waitcnt lgkmcnt(5)
  v_mfma_f32_32x32x16_bf16 v[32:47], v[92:95], v[88:91], v[32:47]
  s_barrier
  ds_read_b128 v[76:79], v24 offset:32768
  ds_read_b64_tr_b16 v[80:81], v8 offset:16384
  ds_read_b64_tr_b16 v[82:83], v8 offset:16896
  v_mfma_f32_32x32x16_bf16 v[48:63], v[96:99], v[88:91], v[48:63]
  ds_read_b64_tr_b16 v[84:85], v9 offset:16384
  ds_read_b64_tr_b16 v[86:87], v9 offset:16896
  s_waitcnt lgkmcnt(5)
  v_mfma_f32_32x32x16_bf16 v[32:47], v[68:71], v[64:67], v[32:47]
  ds_read_b128 v[88:91], v25 offset:32768
  ds_read_b64_tr_b16 v[92:93], v8 offset:18432
  ds_read_b64_tr_b16 v[94:95], v8 offset:18944
  v_mfma_f32_32x32x16_bf16 v[48:63], v[72:75], v[64:67], v[48:63]
  ds_read_b64_tr_b16 v[96:97], v9 offset:18432
  ds_read_b64_tr_b16 v[98:99], v9 offset:18944
  s_waitcnt lgkmcnt(5)
  v_mfma_f32_32x32x16_bf16 v[32:47], v[80:83], v[76:79], v[32:47]
  ds_read_b128 v[64:67], v26 offset:32768
  ds_read_b64_tr_b16 v[68:69], v8 offset:20480
  ds_read_b64_tr_b16 v[70:71], v8 offset:20992
  v_mfma_f32_32x32x16_bf16 v[48:63], v[84:87], v[76:79], v[48:63]
  ds_read_b64_tr_b16 v[72:73], v9 offset:20480
  ds_read_b64_tr_b16 v[74:75], v9 offset:20992
  s_waitcnt lgkmcnt(5)
  v_mfma_f32_32x32x16_bf16 v[32:47], v[92:95], v[88:91], v[32:47]
  ds_read_b128 v[76:79], v27 offset:32768
  ds_read_b64_tr_b16 v[80:81], v8 offset:22528
  ds_read_b64_tr_b16 v[82:83], v8 offset:23040
  v_mfma_f32_32x32x16_bf16 v[48:63], v[96:99], v[88:91], v[48:63]
  ds_read_b64_tr_b16 v[84:85], v9 offset:22528
  ds_read_b64_tr_b16 v[86:87], v9 offset:23040
  ds_read_b128 v[100:103], v28 offset:57344
  ds_read_b128 v[104:107], v29 offset:57344
  ds_read_b128 v[108:111], v30 offset:57344
  ds_read_b128 v[112:115], v31 offset:57344
  ds_read_b64 v[22:23], v6
  s_waitcnt lgkmcnt(5)
  v_mfma_f32_32x32x16_bf16 v[32:47], v[68:71], v[64:67], v[32:47]
  v_mfma_f32_32x32x16_bf16 v[48:63], v[72:75], v[64:67], v[48:63]
  s_waitcnt lgkmcnt(0)
  v_mfma_f32_32x32x16_bf16 v[32:47], v[80:83], v[76:79], v[32:47]
  v_mfma_f32_32x32x16_bf16 v[48:63], v[84:87], v[76:79], v[48:63]
  v_lshlrev_b32 v116, 16, v100
  v_and_b32 v117, 0xffff0000, v100
  v_lshlrev_b32 v118, 16, v101
  v_and_b32 v119, 0xffff0000, v101
  v_lshlrev_b32 v120, 16, v102
  v_and_b32 v121, 0xffff0000, v102
  v_lshlrev_b32 v122, 16, v103
  v_and_b32 v123, 0xffff0000, v103
  v_lshlrev_b32 v124, 16, v104
  v_and_b32 v125, 0xffff0000, v104
  v_lshlrev_b32 v126, 16, v105
  v_and_b32 v127, 0xffff0000, v105
  v_lshlrev_b32 v128, 16, v106
  v_and_b32 v129, 0xffff0000, v106
  v_lshlrev_b32 v130, 16, v107
  v_and_b32 v131, 0xffff0000, v107
  v_lshlrev_b32 v132, 16, v108
  v_and_b32 v133, 0xffff0000, v108
  v_lshlrev_b32 v134, 16, v109
  v_and_b32 v135, 0xffff0000, v109
  v_lshlrev_b32 v136, 16, v110
  v_and_b32 v137, 0xffff0000, v110
  v_lshlrev_b32 v138, 16, v111
  v_and_b32 v139, 0xffff0000, v111
  v_lshlrev_b32 v140, 16, v112
  v_and_b32 v141, 0xffff0000, v112
  v_lshlrev_b32 v142, 16, v113
  v_and_b32 v143, 0xffff0000, v113
  v_lshlrev_b32 v144, 16, v114
  v_and_b32 v145, 0xffff0000, v114
  v_lshlrev_b32 v146, 16, v115
  v_and_b32 v147, 0xffff0000, v115
  v_pk_add_f32 v[116:117], v[116:117], v[32:33]
  v_pk_add_f32 v[118:119], v[118:119], v[34:35]
  v_pk_add_f32 v[120:121], v[120:121], v[36:37]
  v_pk_add_f32 v[122:123], v[122:123], v[38:39]
  v_pk_add_f32 v[124:125], v[124:125], v[40:41]
  v_pk_add_f32 v[126:127], v[126:127], v[42:43]
  v_pk_add_f32 v[128:129], v[128:129], v[44:45]
  v_pk_add_f32 v[130:131], v[130:131], v[46:47]
  v_pk_add_f32 v[132:133], v[132:133], v[48:49]
  v_pk_add_f32 v[134:135], v[134:135], v[50:51]
  v_pk_add_f32 v[136:137], v[136:137], v[52:53]
  v_pk_add_f32 v[138:139], v[138:139], v[54:55]
  v_pk_add_f32 v[140:141], v[140:141], v[56:57]
  v_pk_add_f32 v[142:143], v[142:143], v[58:59]
  v_pk_add_f32 v[144:145], v[144:145], v[60:61]
  v_pk_add_f32 v[146:147], v[146:147], v[62:63]
  v_pk_add_f32 v[64:65], v[116:117], v[118:119]
  v_pk_add_f32 v[66:67], v[120:121], v[122:123]
  v_pk_add_f32 v[68:69], v[124:125], v[126:127]
  v_pk_add_f32 v[70:71], v[128:129], v[130:131]
  v_pk_add_f32 v[72:73], v[132:133], v[134:135]
  v_pk_add_f32 v[74:75], v[136:137], v[138:139]
  v_pk_add_f32 v[76:77], v[140:141], v[142:143]
  v_pk_add_f32 v[78:79], v[144:145], v[146:147]
  v_pk_add_f32 v[64:65], v[64:65], v[72:73]
  v_pk_add_f32 v[66:67], v[66:67], v[74:75]
  v_pk_add_f32 v[68:69], v[68:69], v[76:77]
  v_pk_add_f32 v[70:71], v[70:71], v[78:79]
  v_pk_add_f32 v[64:65], v[64:65], v[68:69]
  v_pk_add_f32 v[66:67], v[66:67], v[70:71]
  v_pk_add_f32 v[64:65], v[64:65], v[66:67]
  v_add_f32 v64, v64, v65
  v_mov_b32 v65, v64
  s_nop 1
  v_permlane32_swap_b32 v64, v65
  s_nop 1
  v_add_f32 v20, v64, v65
  v_mul_f32 v66, 0xbc800000, v20
  v_mul_f32 v67, 0xbc800000, v20

  v_pk_add_f32 v[32:33], v[116:117], v[66:67]
  v_pk_add_f32 v[34:35], v[118:119], v[66:67]
  v_pk_add_f32 v[36:37], v[120:121], v[66:67]
  v_pk_add_f32 v[38:39], v[122:123], v[66:67]
  v_pk_add_f32 v[40:41], v[124:125], v[66:67]
  v_pk_add_f32 v[42:43], v[126:127], v[66:67]
  v_pk_add_f32 v[44:45], v[128:129], v[66:67]
  v_pk_add_f32 v[46:47], v[130:131], v[66:67]
  v_pk_add_f32 v[48:49], v[132:133], v[66:67]
  v_pk_add_f32 v[50:51], v[134:135], v[66:67]
  v_pk_add_f32 v[52:53], v[136:137], v[66:67]
  v_pk_add_f32 v[54:55], v[138:139], v[66:67]
  v_pk_add_f32 v[56:57], v[140:141], v[66:67]
  v_pk_add_f32 v[58:59], v[142:143], v[66:67]
  v_pk_add_f32 v[60:61], v[144:145], v[66:67]
  v_pk_add_f32 v[62:63], v[146:147], v[66:67]
  v_pk_mul_f32 v[68:69], v[32:33], v[32:33]
  v_pk_mul_f32 v[70:71], v[34:35], v[34:35]
  v_pk_fma_f32 v[68:69], v[36:37], v[36:37], v[68:69]
  v_pk_fma_f32 v[70:71], v[38:39], v[38:39], v[70:71]
  v_pk_fma_f32 v[68:69], v[40:41], v[40:41], v[68:69]
  v_pk_fma_f32 v[70:71], v[42:43], v[42:43], v[70:71]
  v_pk_fma_f32 v[68:69], v[44:45], v[44:45], v[68:69]
  v_pk_fma_f32 v[70:71], v[46:47], v[46:47], v[70:71]
  v_pk_fma_f32 v[68:69], v[48:49], v[48:49], v[68:69]
  v_pk_fma_f32 v[70:71], v[50:51], v[50:51], v[70:71]
  v_pk_fma_f32 v[68:69], v[52:53], v[52:53], v[68:69]
  v_pk_fma_f32 v[70:71], v[54:55], v[54:55], v[70:71]
  v_pk_fma_f32 v[68:69], v[56:57], v[56:57], v[68:69]
  v_pk_fma_f32 v[70:71], v[58:59], v[58:59], v[70:71]
  v_pk_fma_f32 v[68:69], v[60:61], v[60:61], v[68:69]
  v_pk_fma_f32 v[70:71], v[62:63], v[62:63], v[70:71]
  v_pk_add_f32 v[68:69], v[68:69], v[70:71]
  v_add_f32 v64, v68, v69
  v_mov_b32 v65, v64
  s_nop 1
  v_permlane32_swap_b32 v64, v65
  s_nop 1
  v_add_f32 v21, v64, v65
  s_mov_b32 exec_hi, 0
  buffer_store_dwordx4 v[20:23], v2, s[56:59], s36 offen
  buffer_store_dwordx4 v[20:23], v2, s[56:59], s37 offen sc1
  s_mov_b32 exec_hi, -1

  s_barrier
  v_cvt_pk_bf16_f32 v64, v116, v117
  v_cvt_pk_bf16_f32 v65, v118, v119
  v_cvt_pk_bf16_f32 v66, v120, v121
  v_cvt_pk_bf16_f32 v67, v122, v123
  v_cvt_pk_bf16_f32 v68, v124, v125
  v_cvt_pk_bf16_f32 v69, v126, v127
  v_cvt_pk_bf16_f32 v70, v128, v129
  v_cvt_pk_bf16_f32 v71, v130, v131
  v_cvt_pk_bf16_f32 v72, v132, v133
  v_cvt_pk_bf16_f32 v73, v134, v135
  v_cvt_pk_bf16_f32 v74, v136, v137
  v_cvt_pk_bf16_f32 v75, v138, v139
  v_cvt_pk_bf16_f32 v76, v140, v141
  v_cvt_pk_bf16_f32 v77, v142, v143
  v_cvt_pk_bf16_f32 v78, v144, v145
  v_cvt_pk_bf16_f32 v79, v146, v147
  s_add_u32 s31, s32, 0
  buffer_store_dwordx4 v[64:67], v199, s[56:59], s31 offen sc1
  s_add_u32 s31, s32, 512
  buffer_store_dwordx4 v[68:71], v199, s[56:59], s31 offen sc1
  s_add_u32 s31, s32, 131072
  buffer_store_dwordx4 v[72:75], v199, s[56:59], s31 offen sc1
  s_add_u32 s31, s32, 131584
  buffer_store_dwordx4 v[76:79], v199, s[56:59], s31 offen sc1
  s_lshl_b32 s35, s30, 6
  s_lshl_b32 s31, s27, 3
  s_add_u32 s35, s35, s31
  s_add_u32 s33, s35, 0xd80000
  s_waitcnt vmcnt(0)

  s_mov_b64 exec, 1
  buffer_store_dwordx2 v[200:201], v204, s[56:59], s33 offen sc1
  s_mov_b64 exec, -1

  s_barrier
  ds_read_b64 v[80:81], v5
  s_waitcnt lgkmcnt(0)
  v_mul_f32 v82, v80, v81
  v_mul_f32 v84, 0xbfb8aa3b, v81
  v_mul_f32 v85, 0xbfb8aa3b, v81
  v_mul_f32 v86, 0x3fb8aa3b, v82
  v_mul_f32 v87, 0x3fb8aa3b, v82
  v_sub_f32 v88, 0, v82
  v_sub_f32 v89, 0, v82
  v_mov_b32 v80, v81
  v_mov_b32 v90, 1.0
  v_mov_b32 v91, 1.0

  v_pk_fma_f32 v[32:33], v[116:117], v[84:85], v[86:87]
  v_pk_fma_f32 v[34:35], v[118:119], v[84:85], v[86:87]
  v_pk_fma_f32 v[36:37], v[120:121], v[84:85], v[86:87]
  v_pk_fma_f32 v[38:39], v[122:123], v[84:85], v[86:87]
  v_exp_f32 v32, v32
  v_exp_f32 v33, v33
  v_exp_f32 v34, v34
  v_exp_f32 v35, v35
  v_exp_f32 v36, v36
  v_exp_f32 v37, v37
  v_exp_f32 v38, v38
  v_exp_f32 v39, v39
  v_pk_fma_f32 v[116:117], v[116:117], v[80:81], v[88:89]
  v_pk_fma_f32 v[118:119], v[118:119], v[80:81], v[88:89]
  v_pk_fma_f32 v[120:121], v[120:121], v[80:81], v[88:89]
  v_pk_fma_f32 v[122:123], v[122:123], v[80:81], v[88:89]
  v_pk_add_f32 v[32:33], v[32:33], v[90:91]
  v_pk_add_f32 v[34:35], v[34:35], v[90:91]
  v_pk_add_f32 v[36:37], v[36:37], v[90:91]
  v_pk_add_f32 v[38:39], v[38:39], v[90:91]
  v_rcp_f32 v32, v32
  v_rcp_f32 v33, v33
  v_rcp_f32 v34, v34
  v_rcp_f32 v35, v35
  v_rcp_f32 v36, v36
  v_rcp_f32 v37, v37
  v_rcp_f32 v38, v38
  v_rcp_f32 v39, v39
  s_nop 0
  v_pk_mul_f32 v[116:117], v[116:117], v[32:33]
  v_pk_mul_f32 v[118:119], v[118:119], v[34:35]
  v_pk_mul_f32 v[120:121], v[120:121], v[36:37]
  v_pk_mul_f32 v[122:123], v[122:123], v[38:39]
  v_cvt_pk_bf16_f32 v100, v116, v117
  v_cvt_pk_bf16_f32 v101, v118, v119
  v_cvt_pk_bf16_f32 v102, v120, v121
  v_cvt_pk_bf16_f32 v103, v122, v123
  s_add_u32 s31, s34, 0
  buffer_store_dwordx4 v[100:103], v199, s[56:59], s31 offen sc1
  v_pk_fma_f32 v[40:41], v[124:125], v[84:85], v[86:87]
  v_pk_fma_f32 v[42:43], v[126:127], v[84:85], v[86:87]
  v_pk_fma_f32 v[44:45], v[128:129], v[84:85], v[86:87]
  v_pk_fma_f32 v[46:47], v[130:131], v[84:85], v[86:87]
  v_exp_f32 v40, v40
  v_exp_f32 v41, v41
  v_exp_f32 v42, v42
  v_exp_f32 v43, v43
  v_exp_f32 v44, v44
  v_exp_f32 v45, v45
  v_exp_f32 v46, v46
  v_exp_f32 v47, v47
  v_pk_fma_f32 v[124:125], v[124:125], v[80:81], v[88:89]
  v_pk_fma_f32 v[126:127], v[126:127], v[80:81], v[88:89]
  v_pk_fma_f32 v[128:129], v[128:129], v[80:81], v[88:89]
  v_pk_fma_f32 v[130:131], v[130:131], v[80:81], v[88:89]
  v_pk_add_f32 v[40:41], v[40:41], v[90:91]
  v_pk_add_f32 v[42:43], v[42:43], v[90:91]
  v_pk_add_f32 v[44:45], v[44:45], v[90:91]
  v_pk_add_f32 v[46:47], v[46:47], v[90:91]
  v_rcp_f32 v40, v40
  v_rcp_f32 v41, v41
  v_rcp_f32 v42, v42
  v_rcp_f32 v43, v43
  v_rcp_f32 v44, v44
  v_rcp_f32 v45, v45
  v_rcp_f32 v46, v46
  v_rcp_f32 v47, v47
  s_nop 0
  v_pk_mul_f32 v[124:125], v[124:125], v[40:41]
  v_pk_mul_f32 v[126:127], v[126:127], v[42:43]
  v_pk_mul_f32 v[128:129], v[128:129], v[44:45]
  v_pk_mul_f32 v[130:131], v[130:131], v[46:47]
  v_cvt_pk_bf16_f32 v104, v124, v125
  v_cvt_pk_bf16_f32 v105, v126, v127
  v_cvt_pk_bf16_f32 v106, v128, v129
  v_cvt_pk_bf16_f32 v107, v130, v131
  s_add_u32 s31, s34, 512
  buffer_store_dwordx4 v[104:107], v199, s[56:59], s31 offen sc1
  v_pk_fma_f32 v[48:49], v[132:133], v[84:85], v[86:87]
  v_pk_fma_f32 v[50:51], v[134:135], v[84:85], v[86:87]
  v_pk_fma_f32 v[52:53], v[136:137], v[84:85], v[86:87]
  v_pk_fma_f32 v[54:55], v[138:139], v[84:85], v[86:87]
  v_exp_f32 v48, v48
  v_exp_f32 v49, v49
  v_exp_f32 v50, v50
  v_exp_f32 v51, v51
  v_exp_f32 v52, v52
  v_exp_f32 v53, v53
  v_exp_f32 v54, v54
  v_exp_f32 v55, v55
  v_pk_fma_f32 v[132:133], v[132:133], v[80:81], v[88:89]
  v_pk_fma_f32 v[134:135], v[134:135], v[80:81], v[88:89]
  v_pk_fma_f32 v[136:137], v[136:137], v[80:81], v[88:89]
  v_pk_fma_f32 v[138:139], v[138:139], v[80:81], v[88:89]
  v_pk_add_f32 v[48:49], v[48:49], v[90:91]
  v_pk_add_f32 v[50:51], v[50:51], v[90:91]
  v_pk_add_f32 v[52:53], v[52:53], v[90:91]
  v_pk_add_f32 v[54:55], v[54:55], v[90:91]
  v_rcp_f32 v48, v48
  v_rcp_f32 v49, v49
  v_rcp_f32 v50, v50
  v_rcp_f32 v51, v51
  v_rcp_f32 v52, v52
  v_rcp_f32 v53, v53
  v_rcp_f32 v54, v54
  v_rcp_f32 v55, v55
  s_nop 0
  v_pk_mul_f32 v[132:133], v[132:133], v[48:49]
  v_pk_mul_f32 v[134:135], v[134:135], v[50:51]
  v_pk_mul_f32 v[136:137], v[136:137], v[52:53]
  v_pk_mul_f32 v[138:139], v[138:139], v[54:55]
  v_cvt_pk_bf16_f32 v108, v132, v133
  v_cvt_pk_bf16_f32 v109, v134, v135
  v_cvt_pk_bf16_f32 v110, v136, v137
  v_cvt_pk_bf16_f32 v111, v138, v139
  s_add_u32 s31, s34, 131072
  buffer_store_dwordx4 v[108:111], v199, s[56:59], s31 offen sc1
  v_pk_fma_f32 v[56:57], v[140:141], v[84:85], v[86:87]
  v_pk_fma_f32 v[58:59], v[142:143], v[84:85], v[86:87]
  v_pk_fma_f32 v[60:61], v[144:145], v[84:85], v[86:87]
  v_pk_fma_f32 v[62:63], v[146:147], v[84:85], v[86:87]
  v_exp_f32 v56, v56
  v_exp_f32 v57, v57
  v_exp_f32 v58, v58
  v_exp_f32 v59, v59
  v_exp_f32 v60, v60
  v_exp_f32 v61, v61
  v_exp_f32 v62, v62
  v_exp_f32 v63, v63
  v_pk_fma_f32 v[140:141], v[140:141], v[80:81], v[88:89]
  v_pk_fma_f32 v[142:143], v[142:143], v[80:81], v[88:89]
  v_pk_fma_f32 v[144:145], v[144:145], v[80:81], v[88:89]
  v_pk_fma_f32 v[146:147], v[146:147], v[80:81], v[88:89]
  v_pk_add_f32 v[56:57], v[56:57], v[90:91]
  v_pk_add_f32 v[58:59], v[58:59], v[90:91]
  v_pk_add_f32 v[60:61], v[60:61], v[90:91]
  v_pk_add_f32 v[62:63], v[62:63], v[90:91]
  v_rcp_f32 v56, v56
  v_rcp_f32 v57, v57
  v_rcp_f32 v58, v58
  v_rcp_f32 v59, v59
  v_rcp_f32 v60, v60
  v_rcp_f32 v61, v61
  v_rcp_f32 v62, v62
  v_rcp_f32 v63, v63
  s_nop 0
  v_pk_mul_f32 v[140:141], v[140:141], v[56:57]
  v_pk_mul_f32 v[142:143], v[142:143], v[58:59]
  v_pk_mul_f32 v[144:145], v[144:145], v[60:61]
  v_pk_mul_f32 v[146:147], v[146:147], v[62:63]
  v_cvt_pk_bf16_f32 v112, v140, v141
  v_cvt_pk_bf16_f32 v113, v142, v143
  v_cvt_pk_bf16_f32 v114, v144, v145
  v_cvt_pk_bf16_f32 v115, v146, v147
  s_add_u32 s31, s34, 131584
  buffer_store_dwordx4 v[112:115], v199, s[56:59], s31 offen sc1
  s_mov_b64 exec, -1
  s_add_u32 s31, s35, 4096
  s_add_u32 s69, s31, 0xd80000
  s_mov_b32 s68, 0
  s_mov_b32 s67, 0
  s_branch P2_entry

K1_FZ:
  s_sub_u32 s27, s25, 16
  s_lshl_b32 s26, s24, 4
  s_add_u32 s26, s26, s27
  s_cmp_lt_u32 s24, 5
  s_cbranch_scc1 K1_F
  s_sub_u32 s28, s24, 5
  s_mul_i32 s26, s28, 12
  s_add_u32 s26, s26, 80
  s_add_u32 s26, s26, s27
  s_cmp_lt_u32 s27, 12
  s_cbranch_scc1 K1_F
  s_lshl_b32 s26, s28, 2
  s_add_u32 s26, s26, s27
  s_add_u32 s26, s26, 108
  s_cmp_lt_u32 s26, 128
  s_cbranch_scc1 K1_Z
  s_branch K1_idle

K1_F:
  s_and_b32 s27, s26, 3
  s_lshr_b32 s26, s26, 2
  s_mul_i32 s30, s26, 160
  s_min_u32 s30, s30, 4448
  s_cmp_lt_u32 s3, 4
  s_cbranch_scc1 K1F_comp

  s_setprio 3
  s_sub_u32 s28, s3, 4
  s_mul_i32 s31, s28, 80
  s_add_u32 s40, s30, s31
  s_lshl_b32 s40, s40, 10
  s_mul_i32 s41, s28, 10240
  v_xor_b32 v19, v14, v12
  v_lshlrev_b32 v6, 10, v12
  v_lshl_add_u32 v6, v19, 6, v6
  v_lshl_add_u32 v6, v15, 4, v6
  s_lshl_b32 s44, s28, 15
  s_lshl_b32 s31, s27, 8
  s_add_u32 s44, s44, s31
  s_lshl_b32 s45, s28, 13
  s_add_u32 s45, s45, 81920
  s_add_u32 s46, s26, s27
  s_lshl_b32 s46, s46, 1
  s_waitcnt lgkmcnt(0)

  v_xor_b32 v19, v11, v16
  v_lshlrev_b32 v20, 10, v10
  v_lshl_add_u32 v20, v19, 4, v20
  s_lshl_b32 s31, s28, 6
  v_xor_b32 v20, s31, v20
  v_xor_b32 v21, 32, v20
  v_xor_b32 v22, 64, v20
  v_xor_b32 v23, 0x60, v20
  v_xor_b32 v7, 32, v6

  s_lshr_b32 s46, s46, 1
  s_mov_b32 s48, s10
  s_mov_b32 s49, s11
  s_mov_b32 s50, 0x80000
  s_mov_b32 s51, 0x20000
  s_mov_b32 s52, s12
  s_mov_b32 s53, s13
  s_mov_b32 s54, 0x480000
  s_mov_b32 s55, 0x20000
  s_add_u32 s42, s46, 0
  s_and_b32 s42, s42, 3
  s_add_u32 s42, s42, 0
  s_lshl_b32 s43, s42, 16
  s_lshl_b32 s42, s42, 7
  s_add_u32 s43, s43, s44
  s_add_u32 s42, s42, s40
  s_add_u32 m0, s45, 0
  s_add_u32 s31, s43, 0
  buffer_load_dwordx4 v6, s[48:51], s31 offen lds
  s_add_u32 m0, s41, 0
  s_add_u32 s31, s42, 0
  buffer_load_dwordx4 v20, s[52:55], s31 offen lds
  s_add_u32 m0, s45, 1024
  s_add_u32 s31, s43, 4096
  buffer_load_dwordx4 v6, s[48:51], s31 offen lds
  s_add_u32 m0, s41, 1024
  s_add_u32 s31, s42, 8192
  buffer_load_dwordx4 v21, s[52:55], s31 offen lds
  s_add_u32 m0, s45, 2048
  s_add_u32 s31, s43, 8192
  buffer_load_dwordx4 v7, s[48:51], s31 offen lds
  s_add_u32 m0, s41, 2048
  s_add_u32 s31, s42, 16384
  buffer_load_dwordx4 v22, s[52:55], s31 offen lds
  s_add_u32 m0, s45, 3072
  s_add_u32 s31, s43, 12288
  buffer_load_dwordx4 v7, s[48:51], s31 offen lds
  s_add_u32 m0, s41, 3072
  s_add_u32 s31, s42, 24576
  buffer_load_dwordx4 v23, s[52:55], s31 offen lds
  s_add_u32 m0, s45, 4096
  s_add_u32 s31, s43, 16384
  buffer_load_dwordx4 v6, s[48:51], s31 offen lds
  s_add_u32 m0, s41, 4096
  s_add_u32 s31, s42, 32768
  buffer_load_dwordx4 v20, s[52:55], s31 offen lds
  s_add_u32 m0, s45, 5120
  s_add_u32 s31, s43, 20480
  buffer_load_dwordx4 v6, s[48:51], s31 offen lds
  s_add_u32 m0, s41, 5120
  s_add_u32 s31, s42, 40960
  buffer_load_dwordx4 v21, s[52:55], s31 offen lds
  s_add_u32 m0, s45, 6144
  s_add_u32 s31, s43, 24576
  buffer_load_dwordx4 v7, s[48:51], s31 offen lds
  s_add_u32 m0, s41, 6144
  s_add_u32 s31, s42, 49152
  buffer_load_dwordx4 v22, s[52:55], s31 offen lds
  s_add_u32 m0, s45, 7168
  s_add_u32 s31, s43, 28672
  buffer_load_dwordx4 v7, s[48:51], s31 offen lds
  s_add_u32 m0, s41, 7168
  s_add_u32 s31, s42, 57344
  buffer_load_dwordx4 v23, s[52:55], s31 offen lds
  s_add_u32 m0, s41, 8192
  s_add_u32 s31, s42, 65536
  buffer_load_dwordx4 v20, s[52:55], s31 offen lds
  s_add_u32 m0, s41, 9216
  s_add_u32 s31, s42, 73728
  buffer_load_dwordx4 v21, s[52:55], s31 offen lds
  s_waitcnt vmcnt(0)
  s_barrier
  s_add_u32 s42, s46, 1
  s_and_b32 s42, s42, 3
  s_add_u32 s42, s42, 0
  s_lshl_b32 s43, s42, 16
  s_lshl_b32 s42, s42, 7
  s_add_u32 s43, s43, s44
  s_add_u32 s42, s42, s40
  s_add_u32 m0, s45, 16384
  s_add_u32 s31, s43, 0
  buffer_load_dwordx4 v6, s[48:51], s31 offen lds
  s_add_u32 m0, s41, 20480
  s_add_u32 s31, s42, 0
  buffer_load_dwordx4 v20, s[52:55], s31 offen lds
  s_add_u32 m0, s45, 17408
  s_add_u32 s31, s43, 4096
  buffer_load_dwordx4 v6, s[48:51], s31 offen lds
  s_add_u32 m0, s41, 21504
  s_add_u32 s31, s42, 8192
  buffer_load_dwordx4 v21, s[52:55], s31 offen lds
  s_add_u32 m0, s45, 18432
  s_add_u32 s31, s43, 8192
  buffer_load_dwordx4 v7, s[48:51], s31 offen lds
  s_add_u32 m0, s41, 22528
  s_add_u32 s31, s42, 16384
  buffer_load_dwordx4 v22, s[52:55], s31 offen lds
  s_add_u32 m0, s45, 19456
  s_add_u32 s31, s43, 12288
  buffer_load_dwordx4 v7, s[48:51], s31 offen lds
  s_add_u32 m0, s41, 23552
  s_add_u32 s31, s42, 24576
  buffer_load_dwordx4 v23, s[52:55], s31 offen lds
  s_add_u32 m0, s45, 20480
  s_add_u32 s31, s43, 16384
  buffer_load_dwordx4 v6, s[48:51], s31 offen lds
  s_add_u32 m0, s41, 24576
  s_add_u32 s31, s42, 32768
  buffer_load_dwordx4 v20, s[52:55], s31 offen lds
  s_add_u32 m0, s45, 21504
  s_add_u32 s31, s43, 20480
  buffer_load_dwordx4 v6, s[48:51], s31 offen lds
  s_add_u32 m0, s41, 25600
  s_add_u32 s31, s42, 40960
  buffer_load_dwordx4 v21, s[52:55], s31 offen lds
  s_add_u32 m0, s45, 22528
  s_add_u32 s31, s43, 24576
  buffer_load_dwordx4 v7, s[48:51], s31 offen lds
  s_add_u32 m0, s41, 26624
  s_add_u32 s31, s42, 49152
  buffer_load_dwordx4 v22, s[52:55], s31 offen lds
  s_add_u32 m0, s45, 23552
  s_add_u32 s31, s43, 28672
  buffer_load_dwordx4 v7, s[48:51], s31 offen lds
  s_add_u32 m0, s41, 27648
  s_add_u32 s31, s42, 57344
  buffer_load_dwordx4 v23, s[52:55], s31 offen lds
  s_add_u32 m0, s41, 28672
  s_add_u32 s31, s42, 65536
  buffer_load_dwordx4 v20, s[52:55], s31 offen lds
  s_add_u32 m0, s41, 29696
  s_add_u32 s31, s42, 73728
  buffer_load_dwordx4 v21, s[52:55], s31 offen lds
  s_add_u32 s42, s46, 2
  s_and_b32 s42, s42, 3
  s_add_u32 s42, s42, 0
  s_lshl_b32 s43, s42, 16
  s_lshl_b32 s42, s42, 7
  s_add_u32 s43, s43, s44
  s_add_u32 s42, s42, s40
  s_add_u32 m0, s45, 32768
  s_add_u32 s31, s43, 0
  buffer_load_dwordx4 v6, s[48:51], s31 offen lds
  s_add_u32 m0, s41, 40960
  s_add_u32 s31, s42, 0
  buffer_load_dwordx4 v20, s[52:55], s31 offen lds
  s_add_u32 m0, s45, 33792
  s_add_u32 s31, s43, 4096
  buffer_load_dwordx4 v6, s[48:51], s31 offen lds
  s_add_u32 m0, s41, 41984
  s_add_u32 s31, s42, 8192
  buffer_load_dwordx4 v21, s[52:55], s31 offen lds
  s_add_u32 m0, s45, 34816
  s_add_u32 s31, s43, 8192
  buffer_load_dwordx4 v7, s[48:51], s31 offen lds
  s_add_u32 m0, s41, 43008
  s_add_u32 s31, s42, 16384
  buffer_load_dwordx4 v22, s[52:55], s31 offen lds
  s_add_u32 m0, s45, 35840
  s_add_u32 s31, s43, 12288
  buffer_load_dwordx4 v7, s[48:51], s31 offen lds
  s_add_u32 m0, s41, 44032
  s_add_u32 s31, s42, 24576
  buffer_load_dwordx4 v23, s[52:55], s31 offen lds
  s_add_u32 m0, s45, 36864
  s_add_u32 s31, s43, 16384
  buffer_load_dwordx4 v6, s[48:51], s31 offen lds
  s_add_u32 m0, s41, 45056
  s_add_u32 s31, s42, 32768
  buffer_load_dwordx4 v20, s[52:55], s31 offen lds
  s_add_u32 m0, s45, 37888
  s_add_u32 s31, s43, 20480
  buffer_load_dwordx4 v6, s[48:51], s31 offen lds
  s_add_u32 m0, s41, 46080
  s_add_u32 s31, s42, 40960
  buffer_load_dwordx4 v21, s[52:55], s31 offen lds
  s_add_u32 m0, s45, 38912
  s_add_u32 s31, s43, 24576
  buffer_load_dwordx4 v7, s[48:51], s31 offen lds
  s_add_u32 m0, s41, 47104
  s_add_u32 s31, s42, 49152
  buffer_load_dwordx4 v22, s[52:55], s31 offen lds
  s_add_u32 m0, s45, 39936
  s_add_u32 s31, s43, 28672
  buffer_load_dwordx4 v7, s[48:51], s31 offen lds
  s_add_u32 m0, s41, 48128
  s_add_u32 s31, s42, 57344
  buffer_load_dwordx4 v23, s[52:55], s31 offen lds
  s_add_u32 m0, s41, 49152
  s_add_u32 s31, s42, 65536
  buffer_load_dwordx4 v20, s[52:55], s31 offen lds
  s_add_u32 m0, s41, 50176
  s_add_u32 s31, s42, 73728
  buffer_load_dwordx4 v21, s[52:55], s31 offen lds
  s_waitcnt vmcnt(18)
  s_barrier
  s_add_u32 s42, s46, 3
  s_and_b32 s42, s42, 3
  s_add_u32 s42, s42, 0
  s_lshl_b32 s43, s42, 16
  s_lshl_b32 s42, s42, 7
  s_add_u32 s43, s43, s44
  s_add_u32 s42, s42, s40
  s_add_u32 m0, s45, 49152
  s_add_u32 s31, s43, 0
  buffer_load_dwordx4 v6, s[48:51], s31 offen lds
  s_add_u32 m0, s41, 61440
  s_add_u32 s31, s42, 0
  buffer_load_dwordx4 v20, s[52:55], s31 offen lds
  s_add_u32 m0, s45, 50176
  s_add_u32 s31, s43, 4096
  buffer_load_dwordx4 v6, s[48:51], s31 offen lds
  s_add_u32 m0, s41, 62464
  s_add_u32 s31, s42, 8192
  buffer_load_dwordx4 v21, s[52:55], s31 offen lds
  s_add_u32 m0, s45, 51200
  s_add_u32 s31, s43, 8192
  buffer_load_dwordx4 v7, s[48:51], s31 offen lds
  s_add_u32 m0, s41, 63488
  s_add_u32 s31, s42, 16384
  buffer_load_dwordx4 v22, s[52:55], s31 offen lds
  s_add_u32 m0, s45, 52224
  s_add_u32 s31, s43, 12288
  buffer_load_dwordx4 v7, s[48:51], s31 offen lds
  s_add_u32 m0, s41, 64512
  s_add_u32 s31, s42, 24576
  buffer_load_dwordx4 v23, s[52:55], s31 offen lds
  s_add_u32 m0, s45, 53248
  s_add_u32 s31, s43, 16384
  buffer_load_dwordx4 v6, s[48:51], s31 offen lds
  s_add_u32 m0, s41, 65536
  s_add_u32 s31, s42, 32768
  buffer_load_dwordx4 v20, s[52:55], s31 offen lds
  s_add_u32 m0, s45, 54272
  s_add_u32 s31, s43, 20480
  buffer_load_dwordx4 v6, s[48:51], s31 offen lds
  s_add_u32 m0, s41, 66560
  s_add_u32 s31, s42, 40960
  buffer_load_dwordx4 v21, s[52:55], s31 offen lds
  s_add_u32 m0, s45, 55296
  s_add_u32 s31, s43, 24576
  buffer_load_dwordx4 v7, s[48:51], s31 offen lds
  s_add_u32 m0, s41, 67584
  s_add_u32 s31, s42, 49152
  buffer_load_dwordx4 v22, s[52:55], s31 offen lds
  s_add_u32 m0, s45, 56320
  s_add_u32 s31, s43, 28672
  buffer_load_dwordx4 v7, s[48:51], s31 offen lds
  s_add_u32 m0, s41, 68608
  s_add_u32 s31, s42, 57344
  buffer_load_dwordx4 v23, s[52:55], s31 offen lds
  s_add_u32 m0, s41, 69632
  s_add_u32 s31, s42, 65536
  buffer_load_dwordx4 v20, s[52:55], s31 offen lds
  s_add_u32 m0, s41, 70656
  s_add_u32 s31, s42, 73728
  buffer_load_dwordx4 v21, s[52:55], s31 offen lds
  s_waitcnt vmcnt(18)
  s_barrier
  s_add_u32 s42, s46, 4
  s_and_b32 s42, s42, 3
  s_add_u32 s42, s42, 4
  s_lshl_b32 s43, s42, 16
  s_lshl_b32 s42, s42, 7
  s_add_u32 s43, s43, s44
  s_add_u32 s42, s42, s40
  s_add_u32 m0, s45, 0
  s_add_u32 s31, s43, 0
  buffer_load_dwordx4 v6, s[48:51], s31 offen lds
  s_add_u32 m0, s41, 0
  s_add_u32 s31, s42, 0
  buffer_load_dwordx4 v20, s[52:55], s31 offen lds
  s_add_u32 m0, s45, 1024
  s_add_u32 s31, s43, 4096
  buffer_load_dwordx4 v6, s[48:51], s31 offen lds
  s_add_u32 m0, s41, 1024
  s_add_u32 s31, s42, 8192
  buffer_load_dwordx4 v21, s[52:55], s31 offen lds
  s_add_u32 m0, s45, 2048
  s_add_u32 s31, s43, 8192
  buffer_load_dwordx4 v7, s[48:51], s31 offen lds
  s_add_u32 m0, s41, 2048
  s_add_u32 s31, s42, 16384
  buffer_load_dwordx4 v22, s[52:55], s31 offen lds
  s_add_u32 m0, s45, 3072
  s_add_u32 s31, s43, 12288
  buffer_load_dwordx4 v7, s[48:51], s31 offen lds
  s_add_u32 m0, s41, 3072
  s_add_u32 s31, s42, 24576
  buffer_load_dwordx4 v23, s[52:55], s31 offen lds
  s_add_u32 m0, s45, 4096
  s_add_u32 s31, s43, 16384
  buffer_load_dwordx4 v6, s[48:51], s31 offen lds
  s_add_u32 m0, s41, 4096
  s_add_u32 s31, s42, 32768
  buffer_load_dwordx4 v20, s[52:55], s31 offen lds
  s_add_u32 m0, s45, 5120
  s_add_u32 s31, s43, 20480
  buffer_load_dwordx4 v6, s[48:51], s31 offen lds
  s_add_u32 m0, s41, 5120
  s_add_u32 s31, s42, 40960
  buffer_load_dwordx4 v21, s[52:55], s31 offen lds
  s_add_u32 m0, s45, 6144
  s_add_u32 s31, s43, 24576
  buffer_load_dwordx4 v7, s[48:51], s31 offen lds
  s_add_u32 m0, s41, 6144
  s_add_u32 s31, s42, 49152
  buffer_load_dwordx4 v22, s[52:55], s31 offen lds
  s_add_u32 m0, s45, 7168
  s_add_u32 s31, s43, 28672
  buffer_load_dwordx4 v7, s[48:51], s31 offen lds
  s_add_u32 m0, s41, 7168
  s_add_u32 s31, s42, 57344
  buffer_load_dwordx4 v23, s[52:55], s31 offen lds
  s_add_u32 m0, s41, 8192
  s_add_u32 s31, s42, 65536
  buffer_load_dwordx4 v20, s[52:55], s31 offen lds
  s_add_u32 m0, s41, 9216
  s_add_u32 s31, s42, 73728
  buffer_load_dwordx4 v21, s[52:55], s31 offen lds
  s_waitcnt vmcnt(18)
  s_barrier
  s_add_u32 s42, s46, 5
  s_and_b32 s42, s42, 3
  s_add_u32 s42, s42, 4
  s_lshl_b32 s43, s42, 16
  s_lshl_b32 s42, s42, 7
  s_add_u32 s43, s43, s44
  s_add_u32 s42, s42, s40
  s_add_u32 m0, s45, 16384
  s_add_u32 s31, s43, 0
  buffer_load_dwordx4 v6, s[48:51], s31 offen lds
  s_add_u32 m0, s41, 20480
  s_add_u32 s31, s42, 0
  buffer_load_dwordx4 v20, s[52:55], s31 offen lds
  s_add_u32 m0, s45, 17408
  s_add_u32 s31, s43, 4096
  buffer_load_dwordx4 v6, s[48:51], s31 offen lds
  s_add_u32 m0, s41, 21504
  s_add_u32 s31, s42, 8192
  buffer_load_dwordx4 v21, s[52:55], s31 offen lds
  s_add_u32 m0, s45, 18432
  s_add_u32 s31, s43, 8192
  buffer_load_dwordx4 v7, s[48:51], s31 offen lds
  s_add_u32 m0, s41, 22528
  s_add_u32 s31, s42, 16384
  buffer_load_dwordx4 v22, s[52:55], s31 offen lds
  s_add_u32 m0, s45, 19456
  s_add_u32 s31, s43, 12288
  buffer_load_dwordx4 v7, s[48:51], s31 offen lds
  s_add_u32 m0, s41, 23552
  s_add_u32 s31, s42, 24576
  buffer_load_dwordx4 v23, s[52:55], s31 offen lds
  s_add_u32 m0, s45, 20480
  s_add_u32 s31, s43, 16384
  buffer_load_dwordx4 v6, s[48:51], s31 offen lds
  s_add_u32 m0, s41, 24576
  s_add_u32 s31, s42, 32768
  buffer_load_dwordx4 v20, s[52:55], s31 offen lds
  s_add_u32 m0, s45, 21504
  s_add_u32 s31, s43, 20480
  buffer_load_dwordx4 v6, s[48:51], s31 offen lds
  s_add_u32 m0, s41, 25600
  s_add_u32 s31, s42, 40960
  buffer_load_dwordx4 v21, s[52:55], s31 offen lds
  s_add_u32 m0, s45, 22528
  s_add_u32 s31, s43, 24576
  buffer_load_dwordx4 v7, s[48:51], s31 offen lds
  s_add_u32 m0, s41, 26624
  s_add_u32 s31, s42, 49152
  buffer_load_dwordx4 v22, s[52:55], s31 offen lds
  s_add_u32 m0, s45, 23552
  s_add_u32 s31, s43, 28672
  buffer_load_dwordx4 v7, s[48:51], s31 offen lds
  s_add_u32 m0, s41, 27648
  s_add_u32 s31, s42, 57344
  buffer_load_dwordx4 v23, s[52:55], s31 offen lds
  s_add_u32 m0, s41, 28672
  s_add_u32 s31, s42, 65536
  buffer_load_dwordx4 v20, s[52:55], s31 offen lds
  s_add_u32 m0, s41, 29696
  s_add_u32 s31, s42, 73728
  buffer_load_dwordx4 v21, s[52:55], s31 offen lds
  s_waitcnt vmcnt(18)
  s_barrier
  s_add_u32 s42, s46, 6
  s_and_b32 s42, s42, 3
  s_add_u32 s42, s42, 4
  s_lshl_b32 s43, s42, 16
  s_lshl_b32 s42, s42, 7
  s_add_u32 s43, s43, s44
  s_add_u32 s42, s42, s40
  s_add_u32 m0, s45, 32768
  s_add_u32 s31, s43, 0
  buffer_load_dwordx4 v6, s[48:51], s31 offen lds
  s_add_u32 m0, s41, 40960
  s_add_u32 s31, s42, 0
  buffer_load_dwordx4 v20, s[52:55], s31 offen lds
  s_add_u32 m0, s45, 33792
  s_add_u32 s31, s43, 4096
  buffer_load_dwordx4 v6, s[48:51], s31 offen lds
  s_add_u32 m0, s41, 41984
  s_add_u32 s31, s42, 8192
  buffer_load_dwordx4 v21, s[52:55], s31 offen lds
  s_add_u32 m0, s45, 34816
  s_add_u32 s31, s43, 8192
  buffer_load_dwordx4 v7, s[48:51], s31 offen lds
  s_add_u32 m0, s41, 43008
  s_add_u32 s31, s42, 16384
  buffer_load_dwordx4 v22, s[52:55], s31 offen lds
  s_add_u32 m0, s45, 35840
  s_add_u32 s31, s43, 12288
  buffer_load_dwordx4 v7, s[48:51], s31 offen lds
  s_add_u32 m0, s41, 44032
  s_add_u32 s31, s42, 24576
  buffer_load_dwordx4 v23, s[52:55], s31 offen lds
  s_add_u32 m0, s45, 36864
  s_add_u32 s31, s43, 16384
  buffer_load_dwordx4 v6, s[48:51], s31 offen lds
  s_add_u32 m0, s41, 45056
  s_add_u32 s31, s42, 32768
  buffer_load_dwordx4 v20, s[52:55], s31 offen lds
  s_add_u32 m0, s45, 37888
  s_add_u32 s31, s43, 20480
  buffer_load_dwordx4 v6, s[48:51], s31 offen lds
  s_add_u32 m0, s41, 46080
  s_add_u32 s31, s42, 40960
  buffer_load_dwordx4 v21, s[52:55], s31 offen lds
  s_add_u32 m0, s45, 38912
  s_add_u32 s31, s43, 24576
  buffer_load_dwordx4 v7, s[48:51], s31 offen lds
  s_add_u32 m0, s41, 47104
  s_add_u32 s31, s42, 49152
  buffer_load_dwordx4 v22, s[52:55], s31 offen lds
  s_add_u32 m0, s45, 39936
  s_add_u32 s31, s43, 28672
  buffer_load_dwordx4 v7, s[48:51], s31 offen lds
  s_add_u32 m0, s41, 48128
  s_add_u32 s31, s42, 57344
  buffer_load_dwordx4 v23, s[52:55], s31 offen lds
  s_add_u32 m0, s41, 49152
  s_add_u32 s31, s42, 65536
  buffer_load_dwordx4 v20, s[52:55], s31 offen lds
  s_add_u32 m0, s41, 50176
  s_add_u32 s31, s42, 73728
  buffer_load_dwordx4 v21, s[52:55], s31 offen lds
  s_waitcnt vmcnt(18)
  s_barrier
  s_add_u32 s42, s46, 7
  s_and_b32 s42, s42, 3
  s_add_u32 s42, s42, 4
  s_lshl_b32 s43, s42, 16
  s_lshl_b32 s42, s42, 7
  s_add_u32 s43, s43, s44
  s_add_u32 s42, s42, s40
  s_add_u32 m0, s45, 49152
  s_add_u32 s31, s43, 0
  buffer_load_dwordx4 v6, s[48:51], s31 offen lds
  s_add_u32 m0, s41, 61440
  s_add_u32 s31, s42, 0
  buffer_load_dwordx4 v20, s[52:55], s31 offen lds
  s_add_u32 m0, s45, 50176
  s_add_u32 s31, s43, 4096
  buffer_load_dwordx4 v6, s[48:51], s31 offen lds
  s_add_u32 m0, s41, 62464
  s_add_u32 s31, s42, 8192
  buffer_load_dwordx4 v21, s[52:55], s31 offen lds
  s_add_u32 m0, s45, 51200
  s_add_u32 s31, s43, 8192
  buffer_load_dwordx4 v7, s[48:51], s31 offen lds
  s_add_u32 m0, s41, 63488
  s_add_u32 s31, s42, 16384
  buffer_load_dwordx4 v22, s[52:55], s31 offen lds
  s_add_u32 m0, s45, 52224
  s_add_u32 s31, s43, 12288
  buffer_load_dwordx4 v7, s[48:51], s31 offen lds
  s_add_u32 m0, s41, 64512
  s_add_u32 s31, s42, 24576
  buffer_load_dwordx4 v23, s[52:55], s31 offen lds
  s_add_u32 m0, s45, 53248
  s_add_u32 s31, s43, 16384
  buffer_load_dwordx4 v6, s[48:51], s31 offen lds
  s_add_u32 m0, s41, 65536
  s_add_u32 s31, s42, 32768
  buffer_load_dwordx4 v20, s[52:55], s31 offen lds
  s_add_u32 m0, s45, 54272
  s_add_u32 s31, s43, 20480
  buffer_load_dwordx4 v6, s[48:51], s31 offen lds
  s_add_u32 m0, s41, 66560
  s_add_u32 s31, s42, 40960
  buffer_load_dwordx4 v21, s[52:55], s31 offen lds
  s_add_u32 m0, s45, 55296
  s_add_u32 s31, s43, 24576
  buffer_load_dwordx4 v7, s[48:51], s31 offen lds
  s_add_u32 m0, s41, 67584
  s_add_u32 s31, s42, 49152
  buffer_load_dwordx4 v22, s[52:55], s31 offen lds
  s_add_u32 m0, s45, 56320
  s_add_u32 s31, s43, 28672
  buffer_load_dwordx4 v7, s[48:51], s31 offen lds
  s_add_u32 m0, s41, 68608
  s_add_u32 s31, s42, 57344
  buffer_load_dwordx4 v23, s[52:55], s31 offen lds
  s_add_u32 m0, s41, 69632
  s_add_u32 s31, s42, 65536
  buffer_load_dwordx4 v20, s[52:55], s31 offen lds
  s_add_u32 m0, s41, 70656
  s_add_u32 s31, s42, 73728
  buffer_load_dwordx4 v21, s[52:55], s31 offen lds
  s_waitcnt vmcnt(18)
  s_barrier
  s_waitcnt vmcnt(0)
  s_barrier
  s_endpgm
K1F_comp:
  s_waitcnt lgkmcnt(0)
  s_and_b32 s28, s3, 1
  s_cmp_eq_u32 s28, 0
  s_cselect_b32 s60, s12, s10
  s_cselect_b32 s61, s13, s11
  s_mov_b32 s62, 0x80000
  s_cselect_b32 s62, 4718592, s62
  s_mov_b32 s63, 0x20000
  s_mov_b32 s65, 0x10000
  s_cselect_b32 s65, 0x80, s65
  s_mov_b32 s66, -1
  s_cselect_b32 s67, 0xff, 0
  s_mul_i32 s31, s27, 40
  s_add_u32 s31, s31, s30
  s_lshl_b32 s31, s31, 10
  s_and_b32 s33, s26, 3
  s_lshl_b32 s33, s33, 14
  s_lshl_b32 s34, s27, 8
  s_add_u32 s33, s33, s34
  s_cmp_eq_u32 s28, 0
  s_cselect_b32 s64, s31, s33
  v_lshlrev_b32 v7, 10, v0
  v_lshrrev_b32 v5, 1, v0
  v_lshlrev_b32 v5, 10, v5
  v_and_b32 v8, 1, v0
  v_lshl_add_u32 v5, v8, 7, v5
  s_cselect_b64 vcc, -1, 0
  s_lshr_b32 s31, s3, 1
  s_mul_i32 s31, s31, s65
  s_add_u32 s64, s64, s31
  v_cndmask_b32 v7, v5, v7, vcc

  v_and_b32 v20, 0x13, v18
  v_bfe_u32 v21, v18, 2, 1
  v_lshl_add_u32 v20, v21, 3, v20
  v_bfe_u32 v21, v18, 3, 1
  v_lshl_add_u32 v20, v21, 2, v20
  v_bfe_u32 v21, v20, 1, 3
  v_xor_b32 v21, v21, v17
  v_lshlrev_b32 v22, 7, v20
  v_lshl_add_u32 v24, v21, 4, v22
  v_xor_b32 v25, 32, v24
  v_xor_b32 v26, 64, v24
  v_xor_b32 v27, 0x60, v24
  v_add_u32 v28, 40960, v24
  v_add_u32 v29, 40960, v25
  v_add_u32 v30, 40960, v26
  v_add_u32 v31, 40960, v27
  v_lshl_add_u32 v23, v17, 3, v14
  v_lshlrev_b32 v23, 8, v23
  v_lshl_add_u32 v23, v16, 5, v23
  v_lshl_add_u32 v23, v15, 3, v23
  v_xor_b32 v21, s3, v14
  v_lshl_add_u32 v9, v21, 6, v23
  v_add_u32 v9, 81920, v9

  v_lshl_add_u32 v20, v14, 3, v15
  v_lshrrev_b32 v21, 1, v15
  v_lshl_add_u32 v21, v14, 1, v21
  v_xor_b32 v21, v21, v12
  v_lshlrev_b32 v22, 7, v20
  v_lshl_add_u32 v24, v21, 4, v22
  v_xor_b32 v25, 64, v24
  v_add_u32 v28, 40960, v24
  v_add_u32 v29, 40960, v25
  v_lshl_add_u32 v23, v12, 3, v14
  v_lshlrev_b32 v23, 8, v23
  v_lshl_add_u32 v23, v16, 5, v23
  v_lshl_add_u32 v23, v15, 3, v23
  v_xor_b32 v21, s3, v14
  v_lshl_add_u32 v9, v21, 6, v23
  v_add_u32 v9, 81920, v9
  v_xor_b32 v8, 32, v9

  v_mov_b32 v32, 0
  v_mov_b32 v33, 0
  v_mov_b32 v34, 0
  v_mov_b32 v35, 0
  v_mov_b32 v36, 0
  v_mov_b32 v37, 0
  v_mov_b32 v38, 0
  v_mov_b32 v39, 0
  v_mov_b32 v40, 0
  v_mov_b32 v41, 0
  v_mov_b32 v42, 0
  v_mov_b32 v43, 0
  v_mov_b32 v44, 0
  v_mov_b32 v45, 0
  v_mov_b32 v46, 0
  v_mov_b32 v47, 0
  v_mov_b32 v48, 0
  v_mov_b32 v49, 0
  v_mov_b32 v50, 0
  v_mov_b32 v51, 0
  v_mov_b32 v52, 0
  v_mov_b32 v53, 0
  v_mov_b32 v54, 0
  v_mov_b32 v55, 0
  v_mov_b32 v56, 0
  v_mov_b32 v57, 0
  v_mov_b32 v58, 0
  v_mov_b32 v59, 0
  v_mov_b32 v60, 0
  v_mov_b32 v61, 0
  v_mov_b32 v62, 0
  v_mov_b32 v63, 0
  v_mov_b32 v64, 0
  v_mov_b32 v65, 0
  v_mov_b32 v66, 0
  v_mov_b32 v67, 0
  v_mov_b32 v68, 0
  v_mov_b32 v69, 0
  v_mov_b32 v70, 0
  v_mov_b32 v71, 0
  v_mov_b32 v72, 0
  v_mov_b32 v73, 0
  v_mov_b32 v74, 0
  v_mov_b32 v75, 0
  v_mov_b32 v76, 0
  v_mov_b32 v77, 0
  v_mov_b32 v78, 0
  v_mov_b32 v79, 0
  v_mov_b32 v80, 0
  v_mov_b32 v81, 0
  v_mov_b32 v82, 0
  v_mov_b32 v83, 0
  v_mov_b32 v84, 0
  v_mov_b32 v85, 0
  v_mov_b32 v86, 0
  v_mov_b32 v87, 0
  v_mov_b32 v88, 0
  v_mov_b32 v89, 0
  v_mov_b32 v90, 0
  v_mov_b32 v91, 0
  v_mov_b32 v92, 0
  v_mov_b32 v93, 0
  v_mov_b32 v94, 0
  v_mov_b32 v95, 0
  v_mov_b32 v96, 0
  v_mov_b32 v97, 0
  v_mov_b32 v98, 0
  v_mov_b32 v99, 0
  v_mov_b32 v100, 0
  v_mov_b32 v101, 0
  v_mov_b32 v102, 0
  v_mov_b32 v103, 0
  v_mov_b32 v104, 0
  v_mov_b32 v105, 0
  v_mov_b32 v106, 0
  v_mov_b32 v107, 0
  v_mov_b32 v108, 0
  v_mov_b32 v109, 0
  v_mov_b32 v110, 0
  v_mov_b32 v111, 0
  s_lshl_b32 s33, s27, 2
  s_add_u32 s33, s33, s3

  s_lshl_b32 s33, s33, 4
  s_add_u32 s34, s30, 0
  s_lshr_b32 s31, s34, 9
  s_bfe_u32 s32, s34, 0x40005
  s_add_u32 s32, s32, s33
  s_mul_i32 s32, s32, 10
  s_add_u32 s32, s32, s31
  s_lshl_b32 s32, s32, 11
  s_add_u32 s36, s32, 0x600000
  s_add_u32 s37, s32, 0x600400

  s_add_u32 s34, s30, 32
  s_lshr_b32 s31, s34, 9
  s_bfe_u32 s32, s34, 0x40005
  s_add_u32 s32, s32, s33
  s_mul_i32 s32, s32, 10
  s_add_u32 s32, s32, s31
  s_lshl_b32 s32, s32, 11
  s_add_u32 s38, s32, 0x600000
  s_add_u32 s39, s32, 0x600400

  s_add_u32 s34, s30, 64
  s_lshr_b32 s31, s34, 9
  s_bfe_u32 s32, s34, 0x40005
  s_add_u32 s32, s32, s33
  s_mul_i32 s32, s32, 10
  s_add_u32 s32, s32, s31
  s_lshl_b32 s32, s32, 11
  s_add_u32 s40, s32, 0x600000
  s_add_u32 s41, s32, 0x600400

  s_add_u32 s34, s30, 96
  s_lshr_b32 s31, s34, 9
  s_bfe_u32 s32, s34, 0x40005
  s_add_u32 s32, s32, s33
  s_mul_i32 s32, s32, 10
  s_add_u32 s32, s32, s31
  s_lshl_b32 s32, s32, 11
  s_add_u32 s42, s32, 0x600000
  s_add_u32 s43, s32, 0x600400

  s_add_u32 s34, s30, 128
  s_lshr_b32 s31, s34, 9
  s_bfe_u32 s32, s34, 0x40005
  s_add_u32 s32, s32, s33
  s_mul_i32 s32, s32, 10
  s_add_u32 s32, s32, s31
  s_lshl_b32 s32, s32, 11
  s_add_u32 s44, s32, 0x600000
  s_add_u32 s45, s32, 0x600400

  s_memrealtime s[70:71]
  s_waitcnt lgkmcnt(0)
  s_mov_b32 s56, s18
  s_mov_b32 s57, s19
  s_mov_b32 s58, 0x1000000
  s_mov_b32 s59, 0x20000
  s_mov_b32 s64, s16
  s_mov_b32 s65, s17
  s_mov_b32 s66, 0x100
  s_mov_b32 s67, 0x20000
  v_mov_b32 v204, 0
  s_barrier
  ds_read_b64_tr_b16 v[172:173], v9 offset:0
  ds_read_b64_tr_b16 v[174:175], v9 offset:1024
  ds_read_b64_tr_b16 v[176:177], v8 offset:0
  ds_read_b64_tr_b16 v[178:179], v8 offset:1024
  ds_read_b128 v[112:115], v24 offset:0
  ds_read_b128 v[116:119], v24 offset:4096
  ds_read_b128 v[120:123], v24 offset:8192
  ds_read_b128 v[124:127], v24 offset:12288
  ds_read_b128 v[128:131], v24 offset:16384
  ds_read_b128 v[132:135], v24 offset:512
  ds_read_b128 v[136:139], v24 offset:4608
  ds_read_b128 v[140:143], v24 offset:8704
  ds_read_b128 v[144:147], v24 offset:12800
  ds_read_b128 v[148:151], v24 offset:16896
  s_waitcnt lgkmcnt(5)
  v_mfma_f32_16x16x32_bf16 v[32:35], v[112:115], v[172:175], v[32:35]
  ds_read_b64_tr_b16 v[180:181], v9 offset:8192
  v_mfma_f32_16x16x32_bf16 v[40:43], v[112:115], v[176:179], v[40:43]
  ds_read_b64_tr_b16 v[182:183], v9 offset:9216
  v_mfma_f32_16x16x32_bf16 v[48:51], v[116:119], v[172:175], v[48:51]
  ds_read_b64_tr_b16 v[184:185], v8 offset:8192
  v_mfma_f32_16x16x32_bf16 v[56:59], v[116:119], v[176:179], v[56:59]
  ds_read_b64_tr_b16 v[186:187], v8 offset:9216
  v_mfma_f32_16x16x32_bf16 v[64:67], v[120:123], v[172:175], v[64:67]
  ds_read_b128 v[152:155], v25 offset:0
  v_mfma_f32_16x16x32_bf16 v[72:75], v[120:123], v[176:179], v[72:75]
  ds_read_b128 v[156:159], v25 offset:4096
  v_mfma_f32_16x16x32_bf16 v[80:83], v[124:127], v[172:175], v[80:83]
  ds_read_b128 v[160:163], v25 offset:8192
  v_mfma_f32_16x16x32_bf16 v[88:91], v[124:127], v[176:179], v[88:91]
  ds_read_b128 v[164:167], v25 offset:12288
  v_mfma_f32_16x16x32_bf16 v[96:99], v[128:131], v[172:175], v[96:99]
  ds_read_b128 v[168:171], v25 offset:16384
  v_mfma_f32_16x16x32_bf16 v[104:107], v[128:131], v[176:179], v[104:107]
  s_waitcnt lgkmcnt(9)
  v_mfma_f32_16x16x32_bf16 v[36:39], v[132:135], v[172:175], v[36:39]
  ds_read_b128 v[112:115], v25 offset:512
  v_mfma_f32_16x16x32_bf16 v[44:47], v[132:135], v[176:179], v[44:47]
  ds_read_b128 v[116:119], v25 offset:4608
  v_mfma_f32_16x16x32_bf16 v[52:55], v[136:139], v[172:175], v[52:55]
  ds_read_b128 v[120:123], v25 offset:8704
  v_mfma_f32_16x16x32_bf16 v[60:63], v[136:139], v[176:179], v[60:63]
  ds_read_b128 v[124:127], v25 offset:12800
  v_mfma_f32_16x16x32_bf16 v[68:71], v[140:143], v[172:175], v[68:71]
  ds_read_b128 v[128:131], v25 offset:16896
  v_mfma_f32_16x16x32_bf16 v[76:79], v[140:143], v[176:179], v[76:79]
  v_mfma_f32_16x16x32_bf16 v[84:87], v[144:147], v[172:175], v[84:87]
  v_mfma_f32_16x16x32_bf16 v[92:95], v[144:147], v[176:179], v[92:95]
  v_mfma_f32_16x16x32_bf16 v[100:103], v[148:151], v[172:175], v[100:103]
  v_mfma_f32_16x16x32_bf16 v[108:111], v[148:151], v[176:179], v[108:111]
  s_waitcnt lgkmcnt(5)
  v_mfma_f32_16x16x32_bf16 v[32:35], v[152:155], v[180:183], v[32:35]
  s_barrier
  ds_read_b64_tr_b16 v[172:173], v9 offset:16384
  v_mfma_f32_16x16x32_bf16 v[40:43], v[152:155], v[184:187], v[40:43]
  ds_read_b64_tr_b16 v[174:175], v9 offset:17408
  v_mfma_f32_16x16x32_bf16 v[48:51], v[156:159], v[180:183], v[48:51]
  ds_read_b64_tr_b16 v[176:177], v8 offset:16384
  v_mfma_f32_16x16x32_bf16 v[56:59], v[156:159], v[184:187], v[56:59]
  ds_read_b64_tr_b16 v[178:179], v8 offset:17408
  v_mfma_f32_16x16x32_bf16 v[64:67], v[160:163], v[180:183], v[64:67]
  ds_read_b128 v[132:135], v24 offset:20480
  v_mfma_f32_16x16x32_bf16 v[72:75], v[160:163], v[184:187], v[72:75]
  ds_read_b128 v[136:139], v24 offset:24576
  v_mfma_f32_16x16x32_bf16 v[80:83], v[164:167], v[180:183], v[80:83]
  ds_read_b128 v[140:143], v24 offset:28672
  v_mfma_f32_16x16x32_bf16 v[88:91], v[164:167], v[184:187], v[88:91]
  ds_read_b128 v[144:147], v24 offset:32768
  v_mfma_f32_16x16x32_bf16 v[96:99], v[168:171], v[180:183], v[96:99]
  ds_read_b128 v[148:151], v24 offset:36864
  v_mfma_f32_16x16x32_bf16 v[104:107], v[168:171], v[184:187], v[104:107]
  s_waitcnt lgkmcnt(9)
  v_mfma_f32_16x16x32_bf16 v[36:39], v[112:115], v[180:183], v[36:39]
  ds_read_b128 v[152:155], v24 offset:20992
  v_mfma_f32_16x16x32_bf16 v[44:47], v[112:115], v[184:187], v[44:47]
  ds_read_b128 v[156:159], v24 offset:25088
  v_mfma_f32_16x16x32_bf16 v[52:55], v[116:119], v[180:183], v[52:55]
  ds_read_b128 v[160:163], v24 offset:29184
  v_mfma_f32_16x16x32_bf16 v[60:63], v[116:119], v[184:187], v[60:63]
  ds_read_b128 v[164:167], v24 offset:33280
  v_mfma_f32_16x16x32_bf16 v[68:71], v[120:123], v[180:183], v[68:71]
  ds_read_b128 v[168:171], v24 offset:37376
  v_mfma_f32_16x16x32_bf16 v[76:79], v[120:123], v[184:187], v[76:79]
  v_mfma_f32_16x16x32_bf16 v[84:87], v[124:127], v[180:183], v[84:87]
  v_mfma_f32_16x16x32_bf16 v[92:95], v[124:127], v[184:187], v[92:95]
  v_mfma_f32_16x16x32_bf16 v[100:103], v[128:131], v[180:183], v[100:103]
  v_mfma_f32_16x16x32_bf16 v[108:111], v[128:131], v[184:187], v[108:111]
  s_waitcnt lgkmcnt(5)
  v_mfma_f32_16x16x32_bf16 v[32:35], v[132:135], v[172:175], v[32:35]
  ds_read_b64_tr_b16 v[180:181], v9 offset:24576
  v_mfma_f32_16x16x32_bf16 v[40:43], v[132:135], v[176:179], v[40:43]
  ds_read_b64_tr_b16 v[182:183], v9 offset:25600
  v_mfma_f32_16x16x32_bf16 v[48:51], v[136:139], v[172:175], v[48:51]
  ds_read_b64_tr_b16 v[184:185], v8 offset:24576
  v_mfma_f32_16x16x32_bf16 v[56:59], v[136:139], v[176:179], v[56:59]
  ds_read_b64_tr_b16 v[186:187], v8 offset:25600
  v_mfma_f32_16x16x32_bf16 v[64:67], v[140:143], v[172:175], v[64:67]
  ds_read_b128 v[112:115], v25 offset:20480
  v_mfma_f32_16x16x32_bf16 v[72:75], v[140:143], v[176:179], v[72:75]
  ds_read_b128 v[116:119], v25 offset:24576
  v_mfma_f32_16x16x32_bf16 v[80:83], v[144:147], v[172:175], v[80:83]
  ds_read_b128 v[120:123], v25 offset:28672
  v_mfma_f32_16x16x32_bf16 v[88:91], v[144:147], v[176:179], v[88:91]
  ds_read_b128 v[124:127], v25 offset:32768
  v_mfma_f32_16x16x32_bf16 v[96:99], v[148:151], v[172:175], v[96:99]
  ds_read_b128 v[128:131], v25 offset:36864
  v_mfma_f32_16x16x32_bf16 v[104:107], v[148:151], v[176:179], v[104:107]
  s_waitcnt lgkmcnt(9)
  v_mfma_f32_16x16x32_bf16 v[36:39], v[152:155], v[172:175], v[36:39]
  ds_read_b128 v[132:135], v25 offset:20992
  v_mfma_f32_16x16x32_bf16 v[44:47], v[152:155], v[176:179], v[44:47]
  ds_read_b128 v[136:139], v25 offset:25088
  v_mfma_f32_16x16x32_bf16 v[52:55], v[156:159], v[172:175], v[52:55]
  ds_read_b128 v[140:143], v25 offset:29184
  v_mfma_f32_16x16x32_bf16 v[60:63], v[156:159], v[176:179], v[60:63]
  ds_read_b128 v[144:147], v25 offset:33280
  v_mfma_f32_16x16x32_bf16 v[68:71], v[160:163], v[172:175], v[68:71]
  ds_read_b128 v[148:151], v25 offset:37376
  v_mfma_f32_16x16x32_bf16 v[76:79], v[160:163], v[176:179], v[76:79]
  v_mfma_f32_16x16x32_bf16 v[84:87], v[164:167], v[172:175], v[84:87]
  v_mfma_f32_16x16x32_bf16 v[92:95], v[164:167], v[176:179], v[92:95]
  v_mfma_f32_16x16x32_bf16 v[100:103], v[168:171], v[172:175], v[100:103]
  v_mfma_f32_16x16x32_bf16 v[108:111], v[168:171], v[176:179], v[108:111]
  s_waitcnt lgkmcnt(5)
  v_mfma_f32_16x16x32_bf16 v[32:35], v[112:115], v[180:183], v[32:35]
  s_barrier
  ds_read_b64_tr_b16 v[172:173], v9 offset:32768
  v_mfma_f32_16x16x32_bf16 v[40:43], v[112:115], v[184:187], v[40:43]
  ds_read_b64_tr_b16 v[174:175], v9 offset:33792
  v_mfma_f32_16x16x32_bf16 v[48:51], v[116:119], v[180:183], v[48:51]
  ds_read_b64_tr_b16 v[176:177], v8 offset:32768
  v_mfma_f32_16x16x32_bf16 v[56:59], v[116:119], v[184:187], v[56:59]
  ds_read_b64_tr_b16 v[178:179], v8 offset:33792
  v_mfma_f32_16x16x32_bf16 v[64:67], v[120:123], v[180:183], v[64:67]
  ds_read_b128 v[152:155], v28 offset:0
  v_mfma_f32_16x16x32_bf16 v[72:75], v[120:123], v[184:187], v[72:75]
  ds_read_b128 v[156:159], v28 offset:4096
  v_mfma_f32_16x16x32_bf16 v[80:83], v[124:127], v[180:183], v[80:83]
  ds_read_b128 v[160:163], v28 offset:8192
  v_mfma_f32_16x16x32_bf16 v[88:91], v[124:127], v[184:187], v[88:91]
  ds_read_b128 v[164:167], v28 offset:12288
  v_mfma_f32_16x16x32_bf16 v[96:99], v[128:131], v[180:183], v[96:99]
  ds_read_b128 v[168:171], v28 offset:16384
  v_mfma_f32_16x16x32_bf16 v[104:107], v[128:131], v[184:187], v[104:107]
  s_waitcnt lgkmcnt(9)
  v_mfma_f32_16x16x32_bf16 v[36:39], v[132:135], v[180:183], v[36:39]
  ds_read_b128 v[112:115], v28 offset:512
  v_mfma_f32_16x16x32_bf16 v[44:47], v[132:135], v[184:187], v[44:47]
  ds_read_b128 v[116:119], v28 offset:4608
  v_mfma_f32_16x16x32_bf16 v[52:55], v[136:139], v[180:183], v[52:55]
  ds_read_b128 v[120:123], v28 offset:8704
  v_mfma_f32_16x16x32_bf16 v[60:63], v[136:139], v[184:187], v[60:63]
  ds_read_b128 v[124:127], v28 offset:12800
  v_mfma_f32_16x16x32_bf16 v[68:71], v[140:143], v[180:183], v[68:71]
  ds_read_b128 v[128:131], v28 offset:16896
  v_mfma_f32_16x16x32_bf16 v[76:79], v[140:143], v[184:187], v[76:79]
  v_mfma_f32_16x16x32_bf16 v[84:87], v[144:147], v[180:183], v[84:87]
  v_mfma_f32_16x16x32_bf16 v[92:95], v[144:147], v[184:187], v[92:95]
  v_mfma_f32_16x16x32_bf16 v[100:103], v[148:151], v[180:183], v[100:103]
  v_mfma_f32_16x16x32_bf16 v[108:111], v[148:151], v[184:187], v[108:111]
  s_waitcnt lgkmcnt(5)
  v_mfma_f32_16x16x32_bf16 v[32:35], v[152:155], v[172:175], v[32:35]
  ds_read_b64_tr_b16 v[180:181], v9 offset:40960
  v_mfma_f32_16x16x32_bf16 v[40:43], v[152:155], v[176:179], v[40:43]
  ds_read_b64_tr_b16 v[182:183], v9 offset:41984
  v_mfma_f32_16x16x32_bf16 v[48:51], v[156:159], v[172:175], v[48:51]
  ds_read_b64_tr_b16 v[184:185], v8 offset:40960
  v_mfma_f32_16x16x32_bf16 v[56:59], v[156:159], v[176:179], v[56:59]
  ds_read_b64_tr_b16 v[186:187], v8 offset:41984
  v_mfma_f32_16x16x32_bf16 v[64:67], v[160:163], v[172:175], v[64:67]
  ds_read_b128 v[132:135], v29 offset:0
  v_mfma_f32_16x16x32_bf16 v[72:75], v[160:163], v[176:179], v[72:75]
  ds_read_b128 v[136:139], v29 offset:4096
  v_mfma_f32_16x16x32_bf16 v[80:83], v[164:167], v[172:175], v[80:83]
  ds_read_b128 v[140:143], v29 offset:8192
  v_mfma_f32_16x16x32_bf16 v[88:91], v[164:167], v[176:179], v[88:91]
  ds_read_b128 v[144:147], v29 offset:12288
  v_mfma_f32_16x16x32_bf16 v[96:99], v[168:171], v[172:175], v[96:99]
  ds_read_b128 v[148:151], v29 offset:16384
  v_mfma_f32_16x16x32_bf16 v[104:107], v[168:171], v[176:179], v[104:107]
  s_waitcnt lgkmcnt(9)
  v_mfma_f32_16x16x32_bf16 v[36:39], v[112:115], v[172:175], v[36:39]
  ds_read_b128 v[152:155], v29 offset:512
  v_mfma_f32_16x16x32_bf16 v[44:47], v[112:115], v[176:179], v[44:47]
  ds_read_b128 v[156:159], v29 offset:4608
  v_mfma_f32_16x16x32_bf16 v[52:55], v[116:119], v[172:175], v[52:55]
  ds_read_b128 v[160:163], v29 offset:8704
  v_mfma_f32_16x16x32_bf16 v[60:63], v[116:119], v[176:179], v[60:63]
  ds_read_b128 v[164:167], v29 offset:12800
  v_mfma_f32_16x16x32_bf16 v[68:71], v[120:123], v[172:175], v[68:71]
  ds_read_b128 v[168:171], v29 offset:16896
  v_mfma_f32_16x16x32_bf16 v[76:79], v[120:123], v[176:179], v[76:79]
  v_mfma_f32_16x16x32_bf16 v[84:87], v[124:127], v[172:175], v[84:87]
  v_mfma_f32_16x16x32_bf16 v[92:95], v[124:127], v[176:179], v[92:95]
  v_mfma_f32_16x16x32_bf16 v[100:103], v[128:131], v[172:175], v[100:103]
  v_mfma_f32_16x16x32_bf16 v[108:111], v[128:131], v[176:179], v[108:111]
  s_waitcnt lgkmcnt(5)
  v_mfma_f32_16x16x32_bf16 v[32:35], v[132:135], v[180:183], v[32:35]
  s_barrier
  ds_read_b64_tr_b16 v[172:173], v9 offset:49152
  v_mfma_f32_16x16x32_bf16 v[40:43], v[132:135], v[184:187], v[40:43]
  ds_read_b64_tr_b16 v[174:175], v9 offset:50176
  v_mfma_f32_16x16x32_bf16 v[48:51], v[136:139], v[180:183], v[48:51]
  ds_read_b64_tr_b16 v[176:177], v8 offset:49152
  v_mfma_f32_16x16x32_bf16 v[56:59], v[136:139], v[184:187], v[56:59]
  ds_read_b64_tr_b16 v[178:179], v8 offset:50176
  v_mfma_f32_16x16x32_bf16 v[64:67], v[140:143], v[180:183], v[64:67]
  ds_read_b128 v[112:115], v28 offset:20480
  v_mfma_f32_16x16x32_bf16 v[72:75], v[140:143], v[184:187], v[72:75]
  ds_read_b128 v[116:119], v28 offset:24576
  v_mfma_f32_16x16x32_bf16 v[80:83], v[144:147], v[180:183], v[80:83]
  ds_read_b128 v[120:123], v28 offset:28672
  v_mfma_f32_16x16x32_bf16 v[88:91], v[144:147], v[184:187], v[88:91]
  ds_read_b128 v[124:127], v28 offset:32768
  v_mfma_f32_16x16x32_bf16 v[96:99], v[148:151], v[180:183], v[96:99]
  ds_read_b128 v[128:131], v28 offset:36864
  v_mfma_f32_16x16x32_bf16 v[104:107], v[148:151], v[184:187], v[104:107]
  buffer_load_dwordx2 v[200:201], v204, s[64:67], 0 offen
  s_waitcnt lgkmcnt(9)
  v_mfma_f32_16x16x32_bf16 v[36:39], v[152:155], v[180:183], v[36:39]
  ds_read_b128 v[132:135], v28 offset:20992
  v_mfma_f32_16x16x32_bf16 v[44:47], v[152:155], v[184:187], v[44:47]
  ds_read_b128 v[136:139], v28 offset:25088
  v_mfma_f32_16x16x32_bf16 v[52:55], v[156:159], v[180:183], v[52:55]
  ds_read_b128 v[140:143], v28 offset:29184
  v_mfma_f32_16x16x32_bf16 v[60:63], v[156:159], v[184:187], v[60:63]
  ds_read_b128 v[144:147], v28 offset:33280
  v_mfma_f32_16x16x32_bf16 v[68:71], v[160:163], v[180:183], v[68:71]
  ds_read_b128 v[148:151], v28 offset:37376
  v_mfma_f32_16x16x32_bf16 v[76:79], v[160:163], v[184:187], v[76:79]
  v_mfma_f32_16x16x32_bf16 v[84:87], v[164:167], v[180:183], v[84:87]
  v_mfma_f32_16x16x32_bf16 v[92:95], v[164:167], v[184:187], v[92:95]
  v_mfma_f32_16x16x32_bf16 v[100:103], v[168:171], v[180:183], v[100:103]
  v_mfma_f32_16x16x32_bf16 v[108:111], v[168:171], v[184:187], v[108:111]
  s_waitcnt lgkmcnt(5)
  v_mfma_f32_16x16x32_bf16 v[32:35], v[112:115], v[172:175], v[32:35]
  ds_read_b64_tr_b16 v[180:181], v9 offset:57344
  v_mfma_f32_16x16x32_bf16 v[40:43], v[112:115], v[176:179], v[40:43]
  ds_read_b64_tr_b16 v[182:183], v9 offset:58368
  v_mfma_f32_16x16x32_bf16 v[48:51], v[116:119], v[172:175], v[48:51]
  ds_read_b64_tr_b16 v[184:185], v8 offset:57344
  v_mfma_f32_16x16x32_bf16 v[56:59], v[116:119], v[176:179], v[56:59]
  ds_read_b64_tr_b16 v[186:187], v8 offset:58368
  v_mfma_f32_16x16x32_bf16 v[64:67], v[120:123], v[172:175], v[64:67]
  ds_read_b128 v[152:155], v29 offset:20480
  v_mfma_f32_16x16x32_bf16 v[72:75], v[120:123], v[176:179], v[72:75]
  ds_read_b128 v[156:159], v29 offset:24576
  v_mfma_f32_16x16x32_bf16 v[80:83], v[124:127], v[172:175], v[80:83]
  ds_read_b128 v[160:163], v29 offset:28672
  v_mfma_f32_16x16x32_bf16 v[88:91], v[124:127], v[176:179], v[88:91]
  ds_read_b128 v[164:167], v29 offset:32768
  v_mfma_f32_16x16x32_bf16 v[96:99], v[128:131], v[172:175], v[96:99]
  ds_read_b128 v[168:171], v29 offset:36864
  v_mfma_f32_16x16x32_bf16 v[104:107], v[128:131], v[176:179], v[104:107]
  s_waitcnt lgkmcnt(9)
  v_mfma_f32_16x16x32_bf16 v[36:39], v[132:135], v[172:175], v[36:39]
  ds_read_b128 v[112:115], v29 offset:20992
  v_mfma_f32_16x16x32_bf16 v[44:47], v[132:135], v[176:179], v[44:47]
  ds_read_b128 v[116:119], v29 offset:25088
  v_mfma_f32_16x16x32_bf16 v[52:55], v[136:139], v[172:175], v[52:55]
  ds_read_b128 v[120:123], v29 offset:29184
  v_mfma_f32_16x16x32_bf16 v[60:63], v[136:139], v[176:179], v[60:63]
  ds_read_b128 v[124:127], v29 offset:33280
  v_mfma_f32_16x16x32_bf16 v[68:71], v[140:143], v[172:175], v[68:71]
  ds_read_b128 v[128:131], v29 offset:37376
  v_mfma_f32_16x16x32_bf16 v[76:79], v[140:143], v[176:179], v[76:79]
  v_mfma_f32_16x16x32_bf16 v[84:87], v[144:147], v[172:175], v[84:87]
  v_mfma_f32_16x16x32_bf16 v[92:95], v[144:147], v[176:179], v[92:95]
  v_mfma_f32_16x16x32_bf16 v[100:103], v[148:151], v[172:175], v[100:103]
  v_mfma_f32_16x16x32_bf16 v[108:111], v[148:151], v[176:179], v[108:111]
  s_waitcnt lgkmcnt(5)
  v_mfma_f32_16x16x32_bf16 v[32:35], v[152:155], v[180:183], v[32:35]
  s_barrier
  ds_read_b64_tr_b16 v[172:173], v9 offset:0
  v_mfma_f32_16x16x32_bf16 v[40:43], v[152:155], v[184:187], v[40:43]
  ds_read_b64_tr_b16 v[174:175], v9 offset:1024
  v_mfma_f32_16x16x32_bf16 v[48:51], v[156:159], v[180:183], v[48:51]
  ds_read_b64_tr_b16 v[176:177], v8 offset:0
  v_mfma_f32_16x16x32_bf16 v[56:59], v[156:159], v[184:187], v[56:59]
  ds_read_b64_tr_b16 v[178:179], v8 offset:1024
  v_mfma_f32_16x16x32_bf16 v[64:67], v[160:163], v[180:183], v[64:67]
  ds_read_b128 v[132:135], v24 offset:0
  v_mfma_f32_16x16x32_bf16 v[72:75], v[160:163], v[184:187], v[72:75]
  ds_read_b128 v[136:139], v24 offset:4096
  v_mfma_f32_16x16x32_bf16 v[80:83], v[164:167], v[180:183], v[80:83]
  ds_read_b128 v[140:143], v24 offset:8192
  v_mfma_f32_16x16x32_bf16 v[88:91], v[164:167], v[184:187], v[88:91]
  ds_read_b128 v[144:147], v24 offset:12288
  v_mfma_f32_16x16x32_bf16 v[96:99], v[168:171], v[180:183], v[96:99]
  ds_read_b128 v[148:151], v24 offset:16384
  v_mfma_f32_16x16x32_bf16 v[104:107], v[168:171], v[184:187], v[104:107]
  s_waitcnt lgkmcnt(9)
  v_mfma_f32_16x16x32_bf16 v[36:39], v[112:115], v[180:183], v[36:39]
  ds_read_b128 v[152:155], v24 offset:512
  v_mfma_f32_16x16x32_bf16 v[44:47], v[112:115], v[184:187], v[44:47]
  ds_read_b128 v[156:159], v24 offset:4608
  v_mfma_f32_16x16x32_bf16 v[52:55], v[116:119], v[180:183], v[52:55]
  ds_read_b128 v[160:163], v24 offset:8704
  v_mfma_f32_16x16x32_bf16 v[60:63], v[116:119], v[184:187], v[60:63]
  ds_read_b128 v[164:167], v24 offset:12800
  v_mfma_f32_16x16x32_bf16 v[68:71], v[120:123], v[180:183], v[68:71]
  ds_read_b128 v[168:171], v24 offset:16896
  v_mfma_f32_16x16x32_bf16 v[76:79], v[120:123], v[184:187], v[76:79]
  v_mfma_f32_16x16x32_bf16 v[84:87], v[124:127], v[180:183], v[84:87]
  v_mfma_f32_16x16x32_bf16 v[92:95], v[124:127], v[184:187], v[92:95]
  v_mfma_f32_16x16x32_bf16 v[100:103], v[128:131], v[180:183], v[100:103]
  v_mfma_f32_16x16x32_bf16 v[108:111], v[128:131], v[184:187], v[108:111]
  s_waitcnt lgkmcnt(5)
  v_mfma_f32_16x16x32_bf16 v[32:35], v[132:135], v[172:175], v[32:35]
  ds_read_b64_tr_b16 v[180:181], v9 offset:8192
  v_mfma_f32_16x16x32_bf16 v[40:43], v[132:135], v[176:179], v[40:43]
  ds_read_b64_tr_b16 v[182:183], v9 offset:9216
  v_mfma_f32_16x16x32_bf16 v[48:51], v[136:139], v[172:175], v[48:51]
  ds_read_b64_tr_b16 v[184:185], v8 offset:8192
  v_mfma_f32_16x16x32_bf16 v[56:59], v[136:139], v[176:179], v[56:59]
  ds_read_b64_tr_b16 v[186:187], v8 offset:9216
  v_mfma_f32_16x16x32_bf16 v[64:67], v[140:143], v[172:175], v[64:67]
  ds_read_b128 v[112:115], v25 offset:0
  v_mfma_f32_16x16x32_bf16 v[72:75], v[140:143], v[176:179], v[72:75]
  ds_read_b128 v[116:119], v25 offset:4096
  v_mfma_f32_16x16x32_bf16 v[80:83], v[144:147], v[172:175], v[80:83]
  ds_read_b128 v[120:123], v25 offset:8192
  v_mfma_f32_16x16x32_bf16 v[88:91], v[144:147], v[176:179], v[88:91]
  ds_read_b128 v[124:127], v25 offset:12288
  v_mfma_f32_16x16x32_bf16 v[96:99], v[148:151], v[172:175], v[96:99]
  ds_read_b128 v[128:131], v25 offset:16384
  v_mfma_f32_16x16x32_bf16 v[104:107], v[148:151], v[176:179], v[104:107]
  s_waitcnt lgkmcnt(9)
  v_mfma_f32_16x16x32_bf16 v[36:39], v[152:155], v[172:175], v[36:39]
  ds_read_b128 v[132:135], v25 offset:512
  v_mfma_f32_16x16x32_bf16 v[44:47], v[152:155], v[176:179], v[44:47]
  ds_read_b128 v[136:139], v25 offset:4608
  v_mfma_f32_16x16x32_bf16 v[52:55], v[156:159], v[172:175], v[52:55]
  ds_read_b128 v[140:143], v25 offset:8704
  v_mfma_f32_16x16x32_bf16 v[60:63], v[156:159], v[176:179], v[60:63]
  ds_read_b128 v[144:147], v25 offset:12800
  v_mfma_f32_16x16x32_bf16 v[68:71], v[160:163], v[172:175], v[68:71]
  ds_read_b128 v[148:151], v25 offset:16896
  v_mfma_f32_16x16x32_bf16 v[76:79], v[160:163], v[176:179], v[76:79]
  v_mfma_f32_16x16x32_bf16 v[84:87], v[164:167], v[172:175], v[84:87]
  v_mfma_f32_16x16x32_bf16 v[92:95], v[164:167], v[176:179], v[92:95]
  v_mfma_f32_16x16x32_bf16 v[100:103], v[168:171], v[172:175], v[100:103]
  v_mfma_f32_16x16x32_bf16 v[108:111], v[168:171], v[176:179], v[108:111]
  s_waitcnt lgkmcnt(5)
  v_mfma_f32_16x16x32_bf16 v[32:35], v[112:115], v[180:183], v[32:35]
  s_barrier
  ds_read_b64_tr_b16 v[172:173], v9 offset:16384
  v_mfma_f32_16x16x32_bf16 v[40:43], v[112:115], v[184:187], v[40:43]
  ds_read_b64_tr_b16 v[174:175], v9 offset:17408
  v_mfma_f32_16x16x32_bf16 v[48:51], v[116:119], v[180:183], v[48:51]
  ds_read_b64_tr_b16 v[176:177], v8 offset:16384
  v_mfma_f32_16x16x32_bf16 v[56:59], v[116:119], v[184:187], v[56:59]
  ds_read_b64_tr_b16 v[178:179], v8 offset:17408
  v_mfma_f32_16x16x32_bf16 v[64:67], v[120:123], v[180:183], v[64:67]
  ds_read_b128 v[152:155], v24 offset:20480
  v_mfma_f32_16x16x32_bf16 v[72:75], v[120:123], v[184:187], v[72:75]
  ds_read_b128 v[156:159], v24 offset:24576
  v_mfma_f32_16x16x32_bf16 v[80:83], v[124:127], v[180:183], v[80:83]
  ds_read_b128 v[160:163], v24 offset:28672
  v_mfma_f32_16x16x32_bf16 v[88:91], v[124:127], v[184:187], v[88:91]
  ds_read_b128 v[164:167], v24 offset:32768
  v_mfma_f32_16x16x32_bf16 v[96:99], v[128:131], v[180:183], v[96:99]
  ds_read_b128 v[168:171], v24 offset:36864
  v_mfma_f32_16x16x32_bf16 v[104:107], v[128:131], v[184:187], v[104:107]
  s_waitcnt lgkmcnt(9)
  v_mfma_f32_16x16x32_bf16 v[36:39], v[132:135], v[180:183], v[36:39]
  ds_read_b128 v[112:115], v24 offset:20992
  v_mfma_f32_16x16x32_bf16 v[44:47], v[132:135], v[184:187], v[44:47]
  ds_read_b128 v[116:119], v24 offset:25088
  v_mfma_f32_16x16x32_bf16 v[52:55], v[136:139], v[180:183], v[52:55]
  ds_read_b128 v[120:123], v24 offset:29184
  v_mfma_f32_16x16x32_bf16 v[60:63], v[136:139], v[184:187], v[60:63]
  ds_read_b128 v[124:127], v24 offset:33280
  v_mfma_f32_16x16x32_bf16 v[68:71], v[140:143], v[180:183], v[68:71]
  ds_read_b128 v[128:131], v24 offset:37376
  v_mfma_f32_16x16x32_bf16 v[76:79], v[140:143], v[184:187], v[76:79]
  v_mfma_f32_16x16x32_bf16 v[84:87], v[144:147], v[180:183], v[84:87]
  v_mfma_f32_16x16x32_bf16 v[92:95], v[144:147], v[184:187], v[92:95]
  v_mfma_f32_16x16x32_bf16 v[100:103], v[148:151], v[180:183], v[100:103]
  v_mfma_f32_16x16x32_bf16 v[108:111], v[148:151], v[184:187], v[108:111]
  s_waitcnt lgkmcnt(5)
  v_mfma_f32_16x16x32_bf16 v[32:35], v[152:155], v[172:175], v[32:35]
  ds_read_b64_tr_b16 v[180:181], v9 offset:24576
  v_mfma_f32_16x16x32_bf16 v[40:43], v[152:155], v[176:179], v[40:43]
  ds_read_b64_tr_b16 v[182:183], v9 offset:25600
  v_mfma_f32_16x16x32_bf16 v[48:51], v[156:159], v[172:175], v[48:51]
  ds_read_b64_tr_b16 v[184:185], v8 offset:24576
  v_mfma_f32_16x16x32_bf16 v[56:59], v[156:159], v[176:179], v[56:59]
  ds_read_b64_tr_b16 v[186:187], v8 offset:25600
  v_mfma_f32_16x16x32_bf16 v[64:67], v[160:163], v[172:175], v[64:67]
  ds_read_b128 v[132:135], v25 offset:20480
  v_mfma_f32_16x16x32_bf16 v[72:75], v[160:163], v[176:179], v[72:75]
  ds_read_b128 v[136:139], v25 offset:24576
  v_mfma_f32_16x16x32_bf16 v[80:83], v[164:167], v[172:175], v[80:83]
  ds_read_b128 v[140:143], v25 offset:28672
  v_mfma_f32_16x16x32_bf16 v[88:91], v[164:167], v[176:179], v[88:91]
  ds_read_b128 v[144:147], v25 offset:32768
  v_mfma_f32_16x16x32_bf16 v[96:99], v[168:171], v[172:175], v[96:99]
  ds_read_b128 v[148:151], v25 offset:36864
  v_mfma_f32_16x16x32_bf16 v[104:107], v[168:171], v[176:179], v[104:107]
  s_mov_b32 s33, 0
K1_res2:
  s_waitcnt vmcnt(0)
  v_readfirstlane_b32 s31, v200
  s_add_u32 s33, s33, 1
  s_nop 2
  s_cmp_lg_u32 s31, 0
  s_cbranch_scc1 K1_res2_ok
  s_cmp_ge_u32 s33, 0x40000
  s_cbranch_scc1 K1_res2_ok
  s_sleep 2

  buffer_load_dwordx2 v[200:201], v204, s[64:67], 0 offen sc1
  s_branch K1_res2
K1_res2_ok:
  s_waitcnt lgkmcnt(9)
  v_mfma_f32_16x16x32_bf16 v[36:39], v[112:115], v[172:175], v[36:39]
  ds_read_b128 v[152:155], v25 offset:20992
  v_mfma_f32_16x16x32_bf16 v[44:47], v[112:115], v[176:179], v[44:47]
  ds_read_b128 v[156:159], v25 offset:25088
  v_mfma_f32_16x16x32_bf16 v[52:55], v[116:119], v[172:175], v[52:55]
  ds_read_b128 v[160:163], v25 offset:29184
  v_mfma_f32_16x16x32_bf16 v[60:63], v[116:119], v[176:179], v[60:63]
  ds_read_b128 v[164:167], v25 offset:33280
  v_mfma_f32_16x16x32_bf16 v[68:71], v[120:123], v[172:175], v[68:71]
  ds_read_b128 v[168:171], v25 offset:37376
  v_mfma_f32_16x16x32_bf16 v[76:79], v[120:123], v[176:179], v[76:79]
  v_mfma_f32_16x16x32_bf16 v[84:87], v[124:127], v[172:175], v[84:87]
  v_mfma_f32_16x16x32_bf16 v[92:95], v[124:127], v[176:179], v[92:95]
  v_mfma_f32_16x16x32_bf16 v[100:103], v[128:131], v[172:175], v[100:103]
  v_mfma_f32_16x16x32_bf16 v[108:111], v[128:131], v[176:179], v[108:111]
  s_waitcnt lgkmcnt(5)
  v_mfma_f32_16x16x32_bf16 v[32:35], v[132:135], v[180:183], v[32:35]
  s_barrier
  ds_read_b64_tr_b16 v[172:173], v9 offset:32768
  v_mfma_f32_16x16x32_bf16 v[40:43], v[132:135], v[184:187], v[40:43]
  ds_read_b64_tr_b16 v[174:175], v9 offset:33792
  v_mfma_f32_16x16x32_bf16 v[48:51], v[136:139], v[180:183], v[48:51]
  ds_read_b64_tr_b16 v[176:177], v8 offset:32768
  v_mfma_f32_16x16x32_bf16 v[56:59], v[136:139], v[184:187], v[56:59]
  ds_read_b64_tr_b16 v[178:179], v8 offset:33792
  v_mfma_f32_16x16x32_bf16 v[64:67], v[140:143], v[180:183], v[64:67]
  ds_read_b128 v[112:115], v28 offset:0
  v_mfma_f32_16x16x32_bf16 v[72:75], v[140:143], v[184:187], v[72:75]
  ds_read_b128 v[116:119], v28 offset:4096
  v_mfma_f32_16x16x32_bf16 v[80:83], v[144:147], v[180:183], v[80:83]
  ds_read_b128 v[120:123], v28 offset:8192
  v_mfma_f32_16x16x32_bf16 v[88:91], v[144:147], v[184:187], v[88:91]
  ds_read_b128 v[124:127], v28 offset:12288
  v_mfma_f32_16x16x32_bf16 v[96:99], v[148:151], v[180:183], v[96:99]
  ds_read_b128 v[128:131], v28 offset:16384
  v_mfma_f32_16x16x32_bf16 v[104:107], v[148:151], v[184:187], v[104:107]
  s_waitcnt lgkmcnt(9)
  v_mfma_f32_16x16x32_bf16 v[36:39], v[152:155], v[180:183], v[36:39]
  ds_read_b128 v[132:135], v28 offset:512
  v_mfma_f32_16x16x32_bf16 v[44:47], v[152:155], v[184:187], v[44:47]
  ds_read_b128 v[136:139], v28 offset:4608
  v_mfma_f32_16x16x32_bf16 v[52:55], v[156:159], v[180:183], v[52:55]
  ds_read_b128 v[140:143], v28 offset:8704
  v_mfma_f32_16x16x32_bf16 v[60:63], v[156:159], v[184:187], v[60:63]
  ds_read_b128 v[144:147], v28 offset:12800
  v_mfma_f32_16x16x32_bf16 v[68:71], v[160:163], v[180:183], v[68:71]
  ds_read_b128 v[148:151], v28 offset:16896
  v_mfma_f32_16x16x32_bf16 v[76:79], v[160:163], v[184:187], v[76:79]
  v_mfma_f32_16x16x32_bf16 v[84:87], v[164:167], v[180:183], v[84:87]
  v_mfma_f32_16x16x32_bf16 v[92:95], v[164:167], v[184:187], v[92:95]
  v_mfma_f32_16x16x32_bf16 v[100:103], v[168:171], v[180:183], v[100:103]
  v_mfma_f32_16x16x32_bf16 v[108:111], v[168:171], v[184:187], v[108:111]
  s_waitcnt lgkmcnt(5)
  v_mfma_f32_16x16x32_bf16 v[32:35], v[112:115], v[172:175], v[32:35]
  ds_read_b64_tr_b16 v[180:181], v9 offset:40960
  v_mfma_f32_16x16x32_bf16 v[40:43], v[112:115], v[176:179], v[40:43]
  ds_read_b64_tr_b16 v[182:183], v9 offset:41984
  v_mfma_f32_16x16x32_bf16 v[48:51], v[116:119], v[172:175], v[48:51]
  ds_read_b64_tr_b16 v[184:185], v8 offset:40960
  v_mfma_f32_16x16x32_bf16 v[56:59], v[116:119], v[176:179], v[56:59]
  ds_read_b64_tr_b16 v[186:187], v8 offset:41984
  v_mfma_f32_16x16x32_bf16 v[64:67], v[120:123], v[172:175], v[64:67]
  ds_read_b128 v[152:155], v29 offset:0
  v_mfma_f32_16x16x32_bf16 v[72:75], v[120:123], v[176:179], v[72:75]
  ds_read_b128 v[156:159], v29 offset:4096
  v_mfma_f32_16x16x32_bf16 v[80:83], v[124:127], v[172:175], v[80:83]
  ds_read_b128 v[160:163], v29 offset:8192
  v_mfma_f32_16x16x32_bf16 v[88:91], v[124:127], v[176:179], v[88:91]
  ds_read_b128 v[164:167], v29 offset:12288
  v_mfma_f32_16x16x32_bf16 v[96:99], v[128:131], v[172:175], v[96:99]
  ds_read_b128 v[168:171], v29 offset:16384
  v_mfma_f32_16x16x32_bf16 v[104:107], v[128:131], v[176:179], v[104:107]
  s_waitcnt lgkmcnt(9)
  v_mfma_f32_16x16x32_bf16 v[36:39], v[132:135], v[172:175], v[36:39]
  ds_read_b128 v[112:115], v29 offset:512
  v_mfma_f32_16x16x32_bf16 v[44:47], v[132:135], v[176:179], v[44:47]
  ds_read_b128 v[116:119], v29 offset:4608
  v_mfma_f32_16x16x32_bf16 v[52:55], v[136:139], v[172:175], v[52:55]
  ds_read_b128 v[120:123], v29 offset:8704
  v_mfma_f32_16x16x32_bf16 v[60:63], v[136:139], v[176:179], v[60:63]
  ds_read_b128 v[124:127], v29 offset:12800
  v_mfma_f32_16x16x32_bf16 v[68:71], v[140:143], v[172:175], v[68:71]
  ds_read_b128 v[128:131], v29 offset:16896
  v_mfma_f32_16x16x32_bf16 v[76:79], v[140:143], v[176:179], v[76:79]
  v_mfma_f32_16x16x32_bf16 v[84:87], v[144:147], v[172:175], v[84:87]
  v_mfma_f32_16x16x32_bf16 v[92:95], v[144:147], v[176:179], v[92:95]
  v_mfma_f32_16x16x32_bf16 v[100:103], v[148:151], v[172:175], v[100:103]
  v_mfma_f32_16x16x32_bf16 v[108:111], v[148:151], v[176:179], v[108:111]
  s_waitcnt lgkmcnt(5)
  v_mfma_f32_16x16x32_bf16 v[32:35], v[152:155], v[180:183], v[32:35]
  s_barrier
  ds_read_b64_tr_b16 v[172:173], v9 offset:49152
  v_mfma_f32_16x16x32_bf16 v[40:43], v[152:155], v[184:187], v[40:43]
  ds_read_b64_tr_b16 v[174:175], v9 offset:50176
  v_mfma_f32_16x16x32_bf16 v[48:51], v[156:159], v[180:183], v[48:51]
  ds_read_b64_tr_b16 v[176:177], v8 offset:49152
  v_mfma_f32_16x16x32_bf16 v[56:59], v[156:159], v[184:187], v[56:59]
  ds_read_b64_tr_b16 v[178:179], v8 offset:50176
  v_mfma_f32_16x16x32_bf16 v[64:67], v[160:163], v[180:183], v[64:67]
  ds_read_b128 v[132:135], v28 offset:20480
  v_mfma_f32_16x16x32_bf16 v[72:75], v[160:163], v[184:187], v[72:75]
  ds_read_b128 v[136:139], v28 offset:24576
  v_mfma_f32_16x16x32_bf16 v[80:83], v[164:167], v[180:183], v[80:83]
  ds_read_b128 v[140:143], v28 offset:28672
  v_mfma_f32_16x16x32_bf16 v[88:91], v[164:167], v[184:187], v[88:91]
  ds_read_b128 v[144:147], v28 offset:32768
  v_mfma_f32_16x16x32_bf16 v[96:99], v[168:171], v[180:183], v[96:99]
  ds_read_b128 v[148:151], v28 offset:36864
  v_mfma_f32_16x16x32_bf16 v[104:107], v[168:171], v[184:187], v[104:107]
  s_waitcnt lgkmcnt(9)
  v_mfma_f32_16x16x32_bf16 v[36:39], v[112:115], v[180:183], v[36:39]
  ds_read_b128 v[152:155], v28 offset:20992
  v_mfma_f32_16x16x32_bf16 v[44:47], v[112:115], v[184:187], v[44:47]
  ds_read_b128 v[156:159], v28 offset:25088
  v_mfma_f32_16x16x32_bf16 v[52:55], v[116:119], v[180:183], v[52:55]
  ds_read_b128 v[160:163], v28 offset:29184
  v_mfma_f32_16x16x32_bf16 v[60:63], v[116:119], v[184:187], v[60:63]
  ds_read_b128 v[164:167], v28 offset:33280
  v_mfma_f32_16x16x32_bf16 v[68:71], v[120:123], v[180:183], v[68:71]
  ds_read_b128 v[168:171], v28 offset:37376
  v_mfma_f32_16x16x32_bf16 v[76:79], v[120:123], v[184:187], v[76:79]
  v_mfma_f32_16x16x32_bf16 v[84:87], v[124:127], v[180:183], v[84:87]
  v_mfma_f32_16x16x32_bf16 v[92:95], v[124:127], v[184:187], v[92:95]
  v_mfma_f32_16x16x32_bf16 v[100:103], v[128:131], v[180:183], v[100:103]
  v_mfma_f32_16x16x32_bf16 v[108:111], v[128:131], v[184:187], v[108:111]
  s_waitcnt lgkmcnt(5)
  v_mfma_f32_16x16x32_bf16 v[32:35], v[132:135], v[172:175], v[32:35]
  ds_read_b64_tr_b16 v[180:181], v9 offset:57344
  v_mfma_f32_16x16x32_bf16 v[40:43], v[132:135], v[176:179], v[40:43]
  ds_read_b64_tr_b16 v[182:183], v9 offset:58368
  v_mfma_f32_16x16x32_bf16 v[48:51], v[136:139], v[172:175], v[48:51]
  ds_read_b64_tr_b16 v[184:185], v8 offset:57344
  v_mfma_f32_16x16x32_bf16 v[56:59], v[136:139], v[176:179], v[56:59]
  ds_read_b64_tr_b16 v[186:187], v8 offset:58368
  v_mfma_f32_16x16x32_bf16 v[64:67], v[140:143], v[172:175], v[64:67]
  ds_read_b128 v[112:115], v29 offset:20480
  v_mfma_f32_16x16x32_bf16 v[72:75], v[140:143], v[176:179], v[72:75]
  ds_read_b128 v[116:119], v29 offset:24576
  v_mfma_f32_16x16x32_bf16 v[80:83], v[144:147], v[172:175], v[80:83]
  ds_read_b128 v[120:123], v29 offset:28672
  v_mfma_f32_16x16x32_bf16 v[88:91], v[144:147], v[176:179], v[88:91]
  ds_read_b128 v[124:127], v29 offset:32768
  v_mfma_f32_16x16x32_bf16 v[96:99], v[148:151], v[172:175], v[96:99]
  ds_read_b128 v[128:131], v29 offset:36864
  v_mfma_f32_16x16x32_bf16 v[104:107], v[148:151], v[176:179], v[104:107]
  s_waitcnt lgkmcnt(9)
  v_mfma_f32_16x16x32_bf16 v[36:39], v[152:155], v[172:175], v[36:39]
  ds_read_b128 v[132:135], v29 offset:20992
  v_mfma_f32_16x16x32_bf16 v[44:47], v[152:155], v[176:179], v[44:47]
  ds_read_b128 v[136:139], v29 offset:25088
  v_mfma_f32_16x16x32_bf16 v[52:55], v[156:159], v[172:175], v[52:55]
  ds_read_b128 v[140:143], v29 offset:29184
  v_mfma_f32_16x16x32_bf16 v[60:63], v[156:159], v[176:179], v[60:63]
  ds_read_b128 v[144:147], v29 offset:33280
  v_mfma_f32_16x16x32_bf16 v[68:71], v[160:163], v[172:175], v[68:71]
  ds_read_b128 v[148:151], v29 offset:37376
  v_mfma_f32_16x16x32_bf16 v[76:79], v[160:163], v[176:179], v[76:79]
  v_mfma_f32_16x16x32_bf16 v[84:87], v[164:167], v[172:175], v[84:87]
  v_mfma_f32_16x16x32_bf16 v[92:95], v[164:167], v[176:179], v[92:95]
  v_mfma_f32_16x16x32_bf16 v[100:103], v[168:171], v[172:175], v[100:103]
  v_mfma_f32_16x16x32_bf16 v[108:111], v[168:171], v[176:179], v[108:111]
  s_waitcnt lgkmcnt(5)
  v_mfma_f32_16x16x32_bf16 v[32:35], v[112:115], v[180:183], v[32:35]
  v_mfma_f32_16x16x32_bf16 v[40:43], v[112:115], v[184:187], v[40:43]
  v_mfma_f32_16x16x32_bf16 v[48:51], v[116:119], v[180:183], v[48:51]
  v_mfma_f32_16x16x32_bf16 v[56:59], v[116:119], v[184:187], v[56:59]
  v_mfma_f32_16x16x32_bf16 v[64:67], v[120:123], v[180:183], v[64:67]
  v_mfma_f32_16x16x32_bf16 v[72:75], v[120:123], v[184:187], v[72:75]
  v_mfma_f32_16x16x32_bf16 v[80:83], v[124:127], v[180:183], v[80:83]
  v_mfma_f32_16x16x32_bf16 v[88:91], v[124:127], v[184:187], v[88:91]
  v_mfma_f32_16x16x32_bf16 v[96:99], v[128:131], v[180:183], v[96:99]
  v_mfma_f32_16x16x32_bf16 v[104:107], v[128:131], v[184:187], v[104:107]
  s_waitcnt lgkmcnt(0)
  v_mfma_f32_16x16x32_bf16 v[36:39], v[132:135], v[180:183], v[36:39]
  v_mfma_f32_16x16x32_bf16 v[44:47], v[132:135], v[184:187], v[44:47]
  v_mfma_f32_16x16x32_bf16 v[52:55], v[136:139], v[180:183], v[52:55]
  v_mfma_f32_16x16x32_bf16 v[60:63], v[136:139], v[184:187], v[60:63]
  v_mfma_f32_16x16x32_bf16 v[68:71], v[140:143], v[180:183], v[68:71]
  v_mfma_f32_16x16x32_bf16 v[76:79], v[140:143], v[184:187], v[76:79]
  v_mfma_f32_16x16x32_bf16 v[84:87], v[144:147], v[180:183], v[84:87]
  v_mfma_f32_16x16x32_bf16 v[92:95], v[144:147], v[184:187], v[92:95]
  v_mfma_f32_16x16x32_bf16 v[100:103], v[148:151], v[180:183], v[100:103]
  v_mfma_f32_16x16x32_bf16 v[108:111], v[148:151], v[184:187], v[108:111]
  s_nop 7
  s_cmp_eq_u32 s26, 28
  s_cbranch_scc1 K1F_skip0
  v_cvt_pk_bf16_f32 v112, v32, v33
  v_cvt_pk_bf16_f32 v113, v34, v35
  v_cvt_pk_bf16_f32 v114, v36, v37
  v_cvt_pk_bf16_f32 v115, v38, v39
  buffer_store_dwordx4 v[112:115], v2, s[56:59], s36 offen sc1
  v_cvt_pk_bf16_f32 v116, v40, v41
  v_cvt_pk_bf16_f32 v117, v42, v43
  v_cvt_pk_bf16_f32 v118, v44, v45
  v_cvt_pk_bf16_f32 v119, v46, v47
  buffer_store_dwordx4 v[116:119], v2, s[56:59], s37 offen sc1
K1F_skip0:
  v_cvt_pk_bf16_f32 v120, v48, v49
  v_cvt_pk_bf16_f32 v121, v50, v51
  v_cvt_pk_bf16_f32 v122, v52, v53
  v_cvt_pk_bf16_f32 v123, v54, v55
  buffer_store_dwordx4 v[120:123], v2, s[56:59], s38 offen sc1
  v_cvt_pk_bf16_f32 v124, v56, v57
  v_cvt_pk_bf16_f32 v125, v58, v59
  v_cvt_pk_bf16_f32 v126, v60, v61
  v_cvt_pk_bf16_f32 v127, v62, v63
  buffer_store_dwordx4 v[124:127], v2, s[56:59], s39 offen sc1
  v_cvt_pk_bf16_f32 v128, v64, v65
  v_cvt_pk_bf16_f32 v129, v66, v67
  v_cvt_pk_bf16_f32 v130, v68, v69
  v_cvt_pk_bf16_f32 v131, v70, v71
  buffer_store_dwordx4 v[128:131], v2, s[56:59], s40 offen sc1
  v_cvt_pk_bf16_f32 v132, v72, v73
  v_cvt_pk_bf16_f32 v133, v74, v75
  v_cvt_pk_bf16_f32 v134, v76, v77
  v_cvt_pk_bf16_f32 v135, v78, v79
  buffer_store_dwordx4 v[132:135], v2, s[56:59], s41 offen sc1
  v_cvt_pk_bf16_f32 v136, v80, v81
  v_cvt_pk_bf16_f32 v137, v82, v83
  v_cvt_pk_bf16_f32 v138, v84, v85
  v_cvt_pk_bf16_f32 v139, v86, v87
  buffer_store_dwordx4 v[136:139], v2, s[56:59], s42 offen sc1
  v_cvt_pk_bf16_f32 v140, v88, v89
  v_cvt_pk_bf16_f32 v141, v90, v91
  v_cvt_pk_bf16_f32 v142, v92, v93
  v_cvt_pk_bf16_f32 v143, v94, v95
  buffer_store_dwordx4 v[140:143], v2, s[56:59], s43 offen sc1
  v_cvt_pk_bf16_f32 v144, v96, v97
  v_cvt_pk_bf16_f32 v145, v98, v99
  v_cvt_pk_bf16_f32 v146, v100, v101
  v_cvt_pk_bf16_f32 v147, v102, v103
  buffer_store_dwordx4 v[144:147], v2, s[56:59], s44 offen sc1
  v_cvt_pk_bf16_f32 v148, v104, v105
  v_cvt_pk_bf16_f32 v149, v106, v107
  v_cvt_pk_bf16_f32 v150, v108, v109
  v_cvt_pk_bf16_f32 v151, v110, v111
  buffer_store_dwordx4 v[148:151], v2, s[56:59], s45 offen sc1
  s_mov_b64 exec, -1
  s_lshl_b32 s31, s27, 2
  s_add_u32 s31, s31, s3
  s_lshl_b32 s31, s31, 5
  s_add_u32 s31, s31, s26
  s_lshl_b32 s31, s31, 3
  s_add_u32 s31, s31, 8192
  s_add_u32 s69, s31, 0xd80000
  s_mov_b32 s68, 0
  s_mov_b32 s67, 0
  s_branch P2_entry

K1_Z:
  s_cmp_ge_u32 s3, 4
  s_cbranch_scc1 K1_end
  s_sub_u32 s27, s26, 120
  s_lshl_b32 s26, s27, 2
  s_add_u32 s26, s26, s3
  s_memrealtime s[70:71]
  s_lshl_b32 s29, s26, 14
  s_lshl_b32 s30, s3, 14
  v_xor_b32 v3, 64, v2
  v_xor_b32 v4, 0x80, v2
  v_xor_b32 v5, 0xc0, v2
  v_lshl_add_u32 v23, v17, 3, v14
  v_lshlrev_b32 v23, 10, v23
  v_lshl_add_u32 v23, v16, 5, v23
  v_lshl_add_u32 v23, v15, 3, v23
  v_lshl_add_u32 v24, v14, 6, v23
  v_add_u32 v24, s30, v24
  v_xor_b32 v25, 64, v24
  v_xor_b32 v26, 0x80, v24
  v_xor_b32 v27, 0xc0, v24

  s_lshr_b32 s32, s26, 1
  s_mul_i32 s32, s32, 20480
  s_and_b32 s31, s26, 1
  s_lshl_b32 s31, s31, 9
  s_add_u32 s32, s32, s31
  s_add_u32 s32, s32, 0x604800

  s_waitcnt lgkmcnt(0)
  s_mov_b32 s48, s10
  s_mov_b32 s49, s11
  s_mov_b32 s50, 0x80000
  s_mov_b32 s51, 0x20000
  s_mov_b32 s56, s18
  s_mov_b32 s57, s19
  s_mov_b32 s58, 0x1000000
  s_mov_b32 s59, 0x20000
  s_mov_b32 s64, s16
  s_mov_b32 s65, s17
  s_mov_b32 s66, 0x100
  s_mov_b32 s67, 0x20000
  v_mov_b32 v204, 0
  s_add_u32 m0, s30, 0
  s_add_u32 s31, s29, 0
  buffer_load_dwordx4 v2, s[48:51], s31 offen lds
  s_add_u32 m0, s30, 1024
  s_add_u32 s31, s29, 1024
  buffer_load_dwordx4 v3, s[48:51], s31 offen lds
  s_add_u32 m0, s30, 2048
  s_add_u32 s31, s29, 2048
  buffer_load_dwordx4 v4, s[48:51], s31 offen lds
  s_add_u32 m0, s30, 3072
  s_add_u32 s31, s29, 3072
  buffer_load_dwordx4 v5, s[48:51], s31 offen lds
  s_add_u32 m0, s30, 4096
  s_add_u32 s31, s29, 4096
  buffer_load_dwordx4 v2, s[48:51], s31 offen lds
  s_add_u32 m0, s30, 5120
  s_add_u32 s31, s29, 5120
  buffer_load_dwordx4 v3, s[48:51], s31 offen lds
  s_add_u32 m0, s30, 6144
  s_add_u32 s31, s29, 6144
  buffer_load_dwordx4 v4, s[48:51], s31 offen lds
  s_add_u32 m0, s30, 7168
  s_add_u32 s31, s29, 7168
  buffer_load_dwordx4 v5, s[48:51], s31 offen lds
  s_add_u32 m0, s30, 8192
  s_add_u32 s31, s29, 8192
  buffer_load_dwordx4 v2, s[48:51], s31 offen lds
  s_add_u32 m0, s30, 9216
  s_add_u32 s31, s29, 9216
  buffer_load_dwordx4 v3, s[48:51], s31 offen lds
  s_add_u32 m0, s30, 10240
  s_add_u32 s31, s29, 10240
  buffer_load_dwordx4 v4, s[48:51], s31 offen lds
  s_add_u32 m0, s30, 11264
  s_add_u32 s31, s29, 11264
  buffer_load_dwordx4 v5, s[48:51], s31 offen lds
  s_add_u32 m0, s30, 12288
  s_add_u32 s31, s29, 12288
  buffer_load_dwordx4 v2, s[48:51], s31 offen lds
  s_add_u32 m0, s30, 13312
  s_add_u32 s31, s29, 13312
  buffer_load_dwordx4 v3, s[48:51], s31 offen lds
  s_add_u32 m0, s30, 14336
  s_add_u32 s31, s29, 14336
  buffer_load_dwordx4 v4, s[48:51], s31 offen lds
  s_add_u32 m0, s30, 15360
  s_add_u32 s31, s29, 15360
  buffer_load_dwordx4 v5, s[48:51], s31 offen lds
  s_waitcnt vmcnt(0)
  buffer_load_dwordx2 v[200:201], v204, s[64:67], 0 offen sc1
  ds_read_b64_tr_b16 v[32:33], v24 offset:0
  ds_read_b64_tr_b16 v[34:35], v24 offset:4096
  ds_read_b64_tr_b16 v[36:37], v25 offset:0
  ds_read_b64_tr_b16 v[38:39], v25 offset:4096
  ds_read_b64_tr_b16 v[40:41], v26 offset:0
  ds_read_b64_tr_b16 v[42:43], v26 offset:4096
  ds_read_b64_tr_b16 v[44:45], v27 offset:0
  ds_read_b64_tr_b16 v[46:47], v27 offset:4096
  s_waitcnt lgkmcnt(0)
  s_add_u32 s31, s32, 0
  buffer_store_dwordx4 v[32:35], v199, s[56:59], s31 offen sc1
  s_add_u32 s31, s32, 327680
  buffer_store_dwordx4 v[36:39], v199, s[56:59], s31 offen sc1
  s_add_u32 s31, s32, 655360
  buffer_store_dwordx4 v[40:43], v199, s[56:59], s31 offen sc1
  s_add_u32 s31, s32, 983040
  buffer_store_dwordx4 v[44:47], v199, s[56:59], s31 offen sc1
  ds_read_b64_tr_b16 v[48:49], v24 offset:256
  ds_read_b64_tr_b16 v[50:51], v24 offset:4352
  ds_read_b64_tr_b16 v[52:53], v25 offset:256
  ds_read_b64_tr_b16 v[54:55], v25 offset:4352
  ds_read_b64_tr_b16 v[56:57], v26 offset:256
  ds_read_b64_tr_b16 v[58:59], v26 offset:4352
  ds_read_b64_tr_b16 v[60:61], v27 offset:256
  ds_read_b64_tr_b16 v[62:63], v27 offset:4352
  s_waitcnt lgkmcnt(0)
  s_add_u32 s31, s32, 1310720
  buffer_store_dwordx4 v[48:51], v199, s[56:59], s31 offen sc1
  s_add_u32 s31, s32, 1638400
  buffer_store_dwordx4 v[52:55], v199, s[56:59], s31 offen sc1
  s_add_u32 s31, s32, 1966080
  buffer_store_dwordx4 v[56:59], v199, s[56:59], s31 offen sc1
  s_add_u32 s31, s32, 2293760
  buffer_store_dwordx4 v[60:63], v199, s[56:59], s31 offen sc1
  ds_read_b64_tr_b16 v[64:65], v24 offset:512
  ds_read_b64_tr_b16 v[66:67], v24 offset:4608
  ds_read_b64_tr_b16 v[68:69], v25 offset:512
  ds_read_b64_tr_b16 v[70:71], v25 offset:4608
  ds_read_b64_tr_b16 v[72:73], v26 offset:512
  ds_read_b64_tr_b16 v[74:75], v26 offset:4608
  ds_read_b64_tr_b16 v[76:77], v27 offset:512
  ds_read_b64_tr_b16 v[78:79], v27 offset:4608
  s_waitcnt lgkmcnt(0)
  s_add_u32 s31, s32, 2621440
  buffer_store_dwordx4 v[64:67], v199, s[56:59], s31 offen sc1
  s_add_u32 s31, s32, 2949120
  buffer_store_dwordx4 v[68:71], v199, s[56:59], s31 offen sc1
  s_add_u32 s31, s32, 3276800
  buffer_store_dwordx4 v[72:75], v199, s[56:59], s31 offen sc1
  s_add_u32 s31, s32, 3604480
  buffer_store_dwordx4 v[76:79], v199, s[56:59], s31 offen sc1
  ds_read_b64_tr_b16 v[80:81], v24 offset:768
  ds_read_b64_tr_b16 v[82:83], v24 offset:4864
  ds_read_b64_tr_b16 v[84:85], v25 offset:768
  ds_read_b64_tr_b16 v[86:87], v25 offset:4864
  ds_read_b64_tr_b16 v[88:89], v26 offset:768
  ds_read_b64_tr_b16 v[90:91], v26 offset:4864
  ds_read_b64_tr_b16 v[92:93], v27 offset:768
  ds_read_b64_tr_b16 v[94:95], v27 offset:4864
  s_waitcnt lgkmcnt(0)
  s_add_u32 s31, s32, 3932160
  buffer_store_dwordx4 v[80:83], v199, s[56:59], s31 offen sc1
  s_add_u32 s31, s32, 4259840
  buffer_store_dwordx4 v[84:87], v199, s[56:59], s31 offen sc1
  s_add_u32 s31, s32, 4587520
  buffer_store_dwordx4 v[88:91], v199, s[56:59], s31 offen sc1
  s_add_u32 s31, s32, 4915200
  buffer_store_dwordx4 v[92:95], v199, s[56:59], s31 offen sc1
  s_mov_b32 s33, 0
K1_res3:
  s_waitcnt vmcnt(0)
  v_readfirstlane_b32 s31, v200
  s_add_u32 s33, s33, 1
  s_nop 2
  s_cmp_lg_u32 s31, 0
  s_cbranch_scc1 K1_res3_ok
  s_cmp_ge_u32 s33, 0x40000
  s_cbranch_scc1 K1_res3_ok
  s_sleep 2

  buffer_load_dwordx2 v[200:201], v204, s[64:67], 0 offen sc1
  s_branch K1_res3
K1_res3_ok:
  s_lshl_b32 s31, s26, 3
  s_add_u32 s31, s31, 12288
  s_add_u32 s69, s31, 0xd80000
  s_mov_b32 s68, 3
  s_mov_b32 s67, 0
  s_branch P2_entry

K1_idle:
  s_cmp_ge_u32 s3, 4
  s_cbranch_scc1 K1_end
  s_waitcnt lgkmcnt(0)
  v_mov_b32 v204, 0
  s_mov_b32 s64, s16
  s_mov_b32 s65, s17
  s_mov_b32 s66, 0x100
  s_mov_b32 s67, 0x20000
  s_mov_b32 s56, s18
  s_mov_b32 s57, s19
  s_mov_b32 s58, 0x1000000
  s_mov_b32 s59, 0x20000
  buffer_load_dwordx2 v[200:201], v204, s[64:67], 0 offen sc1
  s_mov_b32 s33, 0
K1_res4:
  s_waitcnt vmcnt(0)
  v_readfirstlane_b32 s31, v200
  s_add_u32 s33, s33, 1
  s_nop 2
  s_cmp_lg_u32 s31, 0
  s_cbranch_scc1 K1_res4_ok
  s_cmp_ge_u32 s33, 0x40000
  s_cbranch_scc1 K1_res4_ok
  s_sleep 2

  buffer_load_dwordx2 v[200:201], v204, s[64:67], 0 offen sc1
  s_branch K1_res4
K1_res4_ok:
K1_idle2:
  s_mov_b32 s68, 4
  s_mov_b32 s69, -1
  s_mov_b32 s67, 0
  s_branch P2_entry
K1_end:
  s_endpgm
P2_entry:
  s_load_dwordx2 s[4:5], s[0:1], 64
  s_load_dwordx2 s[6:7], s[0:1], 0
  s_load_dwordx2 s[20:21], s[0:1], 48

  s_and_b32 s24, s2, 7
  s_lshr_b32 s25, s2, 3
  s_and_b32 s26, s24, 3
  s_lshl_b32 s26, s26, 2
  s_and_b32 s29, s25, 3
  s_add_u32 s26, s26, s29
  s_and_b32 s28, s26, 7
  s_lshl_b32 s26, s26, 2
  s_lshr_b32 s27, s24, 2
  s_lshl_b32 s27, s27, 3
  s_lshr_b32 s29, s25, 2
  s_add_u32 s27, s27, s29
  v_lshlrev_b32 v2, 4, v0
  v_add_u32 v3, 0x1000, v2
  v_add_u32 v4, 0x2000, v2
  v_add_u32 v7, 0x2800, v2
  s_cmp_eq_u32 s28, 0
  s_cselect_b32 s30, 0x40000000, 0
  s_cmp_eq_u32 s28, 7
  s_cselect_b32 s31, 0x40000000, 0
  v_add_u32 v6, s30, v2
  v_add_u32 v7, s31, v7
  s_lshl_b32 s32, s3, 8
  s_add_u32 s32, s32, s26
  s_lshl_b32 s32, s32, 11
  s_add_u32 s33, s32, 0x300000
  s_add_u32 s32, s32, 0x800
  s_lshl_b32 s34, s27, 4
  s_lshl_b32 s35, s3, 2
  s_add_u32 s34, s34, s35
  s_mul_i32 s34, s34, 20480
  s_add_u32 s34, s34, 0x600000

  v_bfe_u32 v1, v0, 2, 2
  v_lshlrev_b32 v1, 13, v1
  v_lshrrev_b32 v8, 5, v0
  v_lshl_add_u32 v1, v8, 12, v1
  v_bfe_u32 v8, v0, 4, 1
  v_lshl_add_u32 v1, v8, 5, v1
  v_and_b32 v8, 3, v0
  v_lshl_add_u32 v1, v8, 3, v1
  s_add_u32 s36, s26, s3
  s_lshl_b32 s36, s36, 15
  s_lshl_b32 s37, s27, 6
  s_add_u32 s36, s36, s37

  v_lshrrev_b32 v96, 1, v0
  v_lshlrev_b32 v96, 6, v96
  v_and_b32 v97, 1, v0
  v_lshl_add_u32 v96, v97, 3, v96
  s_lshl_b32 s38, s26, 6
  s_lshl_b32 s39, s3, 4
  s_add_u32 s38, s38, s39
  v_add_u32 v205, s38, v96
  s_lshl_b32 s39, s26, 6
  s_add_u32 s39, s39, 4032
  v_add_u32 v99, s39, v2
  s_lshl_b32 s39, s27, 8
  s_add_u32 s39, s39, 7808
  v_add_u32 v206, s39, v2
  v_cmp_gt_u32 vcc, 24, v0
  s_nop 1
  v_cndmask_b32 v206, v206, v99, vcc
  v_lshlrev_b32 v96, 3, v0
  s_lshl_b32 s39, s3, 6
  s_add_u32 s39, s39, 12224
  v_add_u32 v97, s39, v96
  v_cmp_gt_u32 vcc, 8, v0
  s_nop 1
  v_cndmask_b32 v205, v97, v205, vcc
  s_mov_b32 s42, -1
  s_cmp_eq_u32 s28, 0
  s_cselect_b32 s42, 0xfffffff0, s42
  s_cmp_eq_u32 s28, 7
  s_cselect_b32 s42, 0xff0fffff, s42
  s_mov_b32 s41, 0xd80000
  s_waitcnt lgkmcnt(0)

  s_mov_b32 s8, s4
  s_mov_b32 s9, s5
  s_mov_b32 s10, 0x1000000
  s_mov_b32 s11, 0x20000
  s_mov_b32 s12, s6
  s_mov_b32 s13, s7
  s_mov_b32 s14, 0x200000
  s_mov_b32 s15, 0x20000
  s_mov_b32 s16, s20
  s_mov_b32 s17, s21
  s_mov_b32 s18, 0x200000
  s_mov_b32 s19, 0x20000
  s_mov_b64 exec, 0xff
  buffer_load_dwordx2 v[202:203], v205, s[8:11], s41 offen sc1
  s_mov_b64 exec, 0xff00
  buffer_load_dwordx2 v[202:203], v205, s[8:11], s41 offen
  s_mov_b64 exec, -1

  v_mov_b32 v16, 0
  v_mov_b32 v17, 0
  v_mov_b32 v18, 0
  v_mov_b32 v19, 0
  v_mov_b32 v20, 0
  v_mov_b32 v21, 0
  v_mov_b32 v22, 0
  v_mov_b32 v23, 0
  v_mov_b32 v24, 0
  v_mov_b32 v25, 0
  v_mov_b32 v26, 0
  v_mov_b32 v27, 0
  v_mov_b32 v28, 0
  v_mov_b32 v29, 0
  v_mov_b32 v30, 0
  v_mov_b32 v31, 0
  v_mov_b32 v32, 0
  v_mov_b32 v33, 0
  v_mov_b32 v34, 0
  v_mov_b32 v35, 0
  v_mov_b32 v36, 0
  v_mov_b32 v37, 0
  v_mov_b32 v38, 0
  v_mov_b32 v39, 0
  v_mov_b32 v40, 0
  v_mov_b32 v41, 0
  v_mov_b32 v42, 0
  v_mov_b32 v43, 0
  v_mov_b32 v44, 0
  v_mov_b32 v45, 0
  v_mov_b32 v46, 0
  v_mov_b32 v47, 0
  v_mov_b32 v48, 0
  v_mov_b32 v49, 0
  v_mov_b32 v50, 0
  v_mov_b32 v51, 0
  v_mov_b32 v52, 0
  v_mov_b32 v53, 0
  v_mov_b32 v54, 0
  v_mov_b32 v55, 0
  v_mov_b32 v56, 0
  v_mov_b32 v57, 0
  v_mov_b32 v58, 0
  v_mov_b32 v59, 0
  v_mov_b32 v60, 0
  v_mov_b32 v61, 0
  v_mov_b32 v62, 0
  v_mov_b32 v63, 0
  v_mov_b32 v64, 0
  v_mov_b32 v65, 0
  v_mov_b32 v66, 0
  v_mov_b32 v67, 0
  v_mov_b32 v68, 0
  v_mov_b32 v69, 0
  v_mov_b32 v70, 0
  v_mov_b32 v71, 0
  v_mov_b32 v72, 0
  v_mov_b32 v73, 0
  v_mov_b32 v74, 0
  v_mov_b32 v75, 0
  v_mov_b32 v76, 0
  v_mov_b32 v77, 0
  v_mov_b32 v78, 0
  v_mov_b32 v79, 0
  v_mov_b32 v80, 0
  v_mov_b32 v81, 0
  v_mov_b32 v82, 0
  v_mov_b32 v83, 0
  v_mov_b32 v84, 0
  v_mov_b32 v85, 0
  v_mov_b32 v86, 0
  v_mov_b32 v87, 0
  v_mov_b32 v88, 0
  v_mov_b32 v89, 0
  v_mov_b32 v90, 0
  v_mov_b32 v91, 0
  v_mov_b32 v92, 0
  v_mov_b32 v93, 0
  v_mov_b32 v94, 0
  v_mov_b32 v95, 0
  v_mov_b32 v96, 0
  v_mov_b32 v97, 0
  v_mov_b32 v98, 0
  v_mov_b32 v99, 0
  v_mov_b32 v100, 0
  v_mov_b32 v101, 0
  v_mov_b32 v102, 0
  v_mov_b32 v103, 0
  v_mov_b32 v104, 0
  v_mov_b32 v105, 0
  v_mov_b32 v106, 0
  v_mov_b32 v107, 0
  v_mov_b32 v108, 0
  v_mov_b32 v109, 0
  v_mov_b32 v110, 0
  v_mov_b32 v111, 0
  s_mov_b32 s40, 0
  s_mov_b64 exec, 0xffff
  s_branch P2_chk1
P2_poll1:
  buffer_load_dwordx2 v[202:203], v205, s[8:11], s41 offen sc1
P2_chk1:
  s_waitcnt vmcnt(0)
  s_cmp_eq_u32 s69, -1
  s_cbranch_scc1 P2_nof
  s_mov_b64 exec, 1
  buffer_store_dwordx2 v[200:201], v204, s[8:11], s69 offen sc1
  s_mov_b64 exec, 0xffff
  s_mov_b32 s69, -1

P2_nof:
  v_xor_b32 v202, v202, v200
  v_xor_b32 v203, v203, v201
  v_or_b32 v202, v202, v203
  v_cmp_ne_u32 vcc, 0, v202
  s_nop 3
  s_cmp_eq_u64 vcc, 0
  s_cbranch_scc1 P2_ok1
  s_add_u32 s40, s40, 1
  s_cmp_ge_u32 s40, 0x40000
  s_cbranch_scc1 P2_ok1
  s_sleep 24
  s_cmp_gt_u32 s40, s68
  s_cbranch_scc1 P2_poll1
  s_sleep 40
  s_branch P2_poll1

P2_ok1:
  s_mov_b64 exec, -1
  s_add_u32 s38, s34, 18432
  s_add_u32 s39, s33, 0
  buffer_load_dwordx4 v[112:115], v2, s[8:11], s38 offen offset:0 sc1
  buffer_load_dwordx4 v[120:123], v2, s[8:11], s39 offen offset:0 sc1
  buffer_load_dwordx4 v[124:127], v2, s[8:11], s39 offen offset:1024 sc1
  buffer_load_dwordx4 v[116:119], v2, s[8:11], s38 offen offset:1024 sc1
  buffer_load_dwordx4 v[128:131], v2, s[8:11], s39 offen offset:2048 sc1
  buffer_load_dwordx4 v[132:135], v2, s[8:11], s39 offen offset:3072 sc1
  buffer_load_dwordx4 v[136:139], v3, s[8:11], s39 offen offset:0 sc1
  buffer_load_dwordx4 v[140:143], v3, s[8:11], s39 offen offset:1024 sc1
  buffer_load_dwordx4 v[144:147], v3, s[8:11], s39 offen offset:2048 sc1
  buffer_load_dwordx4 v[148:151], v3, s[8:11], s39 offen offset:3072 sc1
  s_add_u32 s38, s34, 38912
  s_add_u32 s39, s33, 131072
  buffer_load_dwordx4 v[160:163], v2, s[8:11], s38 offen offset:0 sc1
  buffer_load_dwordx4 v[168:171], v2, s[8:11], s39 offen offset:0 sc1
  buffer_load_dwordx4 v[172:175], v2, s[8:11], s39 offen offset:1024 sc1
  buffer_load_dwordx4 v[164:167], v2, s[8:11], s38 offen offset:1024 sc1
  buffer_load_dwordx4 v[176:179], v2, s[8:11], s39 offen offset:2048 sc1
  s_waitcnt vmcnt(13)
  v_mfma_f32_16x16x32_bf16 v[18:21], v[120:123], v[112:115], v[18:21]
  s_waitcnt vmcnt(11)
  v_mfma_f32_16x16x32_bf16 v[30:33], v[120:123], v[116:119], v[30:33]
  buffer_load_dwordx4 v[180:183], v2, s[8:11], s39 offen offset:3072 sc1
  v_mfma_f32_16x16x32_bf16 v[22:25], v[124:127], v[112:115], v[22:25]
  v_mfma_f32_16x16x32_bf16 v[34:37], v[124:127], v[116:119], v[34:37]
  buffer_load_dwordx4 v[184:187], v3, s[8:11], s39 offen offset:0 sc1
  s_waitcnt vmcnt(12)
  v_mfma_f32_16x16x32_bf16 v[42:45], v[128:131], v[112:115], v[42:45]
  buffer_load_dwordx4 v[188:191], v3, s[8:11], s39 offen offset:1024 sc1
  v_mfma_f32_16x16x32_bf16 v[54:57], v[128:131], v[116:119], v[54:57]
  s_waitcnt vmcnt(12)
  v_mfma_f32_16x16x32_bf16 v[46:49], v[132:135], v[112:115], v[46:49]
  buffer_load_dwordx4 v[192:195], v3, s[8:11], s39 offen offset:2048 sc1
  v_mfma_f32_16x16x32_bf16 v[58:61], v[132:135], v[116:119], v[58:61]
  buffer_load_dwordx4 v[196:199], v3, s[8:11], s39 offen offset:3072 sc1
  s_waitcnt vmcnt(13)
  v_mfma_f32_16x16x32_bf16 v[66:69], v[136:139], v[112:115], v[66:69]
  v_mfma_f32_16x16x32_bf16 v[78:81], v[136:139], v[116:119], v[78:81]
  s_add_u32 s38, s34, 59392
  s_add_u32 s39, s33, 262144
  buffer_load_dwordx4 v[212:215], v2, s[8:11], s38 offen offset:0 sc1
  s_waitcnt vmcnt(13)
  v_mfma_f32_16x16x32_bf16 v[70:73], v[140:143], v[112:115], v[70:73]
  v_mfma_f32_16x16x32_bf16 v[82:85], v[140:143], v[116:119], v[82:85]
  buffer_load_dwordx4 v[220:223], v2, s[8:11], s39 offen offset:0 sc1
  s_waitcnt vmcnt(13)
  v_mfma_f32_16x16x32_bf16 v[90:93], v[144:147], v[112:115], v[90:93]
  buffer_load_dwordx4 v[224:227], v2, s[8:11], s39 offen offset:1024 sc1
  v_mfma_f32_16x16x32_bf16 v[102:105], v[144:147], v[116:119], v[102:105]
  s_waitcnt vmcnt(13)
  v_mfma_f32_16x16x32_bf16 v[94:97], v[148:151], v[112:115], v[94:97]
  buffer_load_dwordx4 v[216:219], v2, s[8:11], s38 offen offset:1024 sc1
  v_mfma_f32_16x16x32_bf16 v[106:109], v[148:151], v[116:119], v[106:109]
  buffer_load_dwordx4 v[228:231], v2, s[8:11], s39 offen offset:2048 sc1
  s_waitcnt vmcnt(13)
  v_mfma_f32_16x16x32_bf16 v[18:21], v[168:171], v[160:163], v[18:21]
  s_waitcnt vmcnt(11)
  v_mfma_f32_16x16x32_bf16 v[30:33], v[168:171], v[164:167], v[30:33]
  buffer_load_dwordx4 v[232:235], v2, s[8:11], s39 offen offset:3072 sc1
  v_mfma_f32_16x16x32_bf16 v[22:25], v[172:175], v[160:163], v[22:25]
  v_mfma_f32_16x16x32_bf16 v[34:37], v[172:175], v[164:167], v[34:37]
  buffer_load_dwordx4 v[236:239], v3, s[8:11], s39 offen offset:0 sc1
  s_waitcnt vmcnt(12)
  v_mfma_f32_16x16x32_bf16 v[42:45], v[176:179], v[160:163], v[42:45]
  buffer_load_dwordx4 v[240:243], v3, s[8:11], s39 offen offset:1024 sc1
  v_mfma_f32_16x16x32_bf16 v[54:57], v[176:179], v[164:167], v[54:57]
  s_waitcnt vmcnt(12)
  v_mfma_f32_16x16x32_bf16 v[46:49], v[180:183], v[160:163], v[46:49]
  buffer_load_dwordx4 v[244:247], v3, s[8:11], s39 offen offset:2048 sc1
  v_mfma_f32_16x16x32_bf16 v[58:61], v[180:183], v[164:167], v[58:61]
  buffer_load_dwordx4 v[248:251], v3, s[8:11], s39 offen offset:3072 sc1
  s_waitcnt vmcnt(13)
  v_mfma_f32_16x16x32_bf16 v[66:69], v[184:187], v[160:163], v[66:69]
  v_mfma_f32_16x16x32_bf16 v[78:81], v[184:187], v[164:167], v[78:81]
  s_cmp_lg_u32 s3, 0
  s_cbranch_scc1 P2_nopl
  s_mov_b32 exec_lo, s42
  s_mov_b32 exec_hi, 0x7f
  buffer_load_dwordx4 v[208:211], v206, s[8:11], s41 offen sc1
  s_mov_b64 exec, -1

P2_nopl:
  s_add_u32 s38, s34, 79872
  s_add_u32 s39, s33, 393216
  buffer_load_dwordx4 v[112:115], v2, s[8:11], s38 offen offset:0 sc1
  s_waitcnt vmcnt(13)
  v_mfma_f32_16x16x32_bf16 v[70:73], v[188:191], v[160:163], v[70:73]
  v_mfma_f32_16x16x32_bf16 v[82:85], v[188:191], v[164:167], v[82:85]
  buffer_load_dwordx4 v[120:123], v2, s[8:11], s39 offen offset:0 sc1
  s_waitcnt vmcnt(13)
  v_mfma_f32_16x16x32_bf16 v[90:93], v[192:195], v[160:163], v[90:93]
  buffer_load_dwordx4 v[124:127], v2, s[8:11], s39 offen offset:1024 sc1
  v_mfma_f32_16x16x32_bf16 v[102:105], v[192:195], v[164:167], v[102:105]
  s_waitcnt vmcnt(13)
  v_mfma_f32_16x16x32_bf16 v[94:97], v[196:199], v[160:163], v[94:97]
  buffer_load_dwordx4 v[116:119], v2, s[8:11], s38 offen offset:1024 sc1
  v_mfma_f32_16x16x32_bf16 v[106:109], v[196:199], v[164:167], v[106:109]
  buffer_load_dwordx4 v[128:131], v2, s[8:11], s39 offen offset:2048 sc1
  s_waitcnt vmcnt(13)
  v_mfma_f32_16x16x32_bf16 v[18:21], v[220:223], v[212:215], v[18:21]
  s_waitcnt vmcnt(11)
  v_mfma_f32_16x16x32_bf16 v[30:33], v[220:223], v[216:219], v[30:33]
  buffer_load_dwordx4 v[132:135], v2, s[8:11], s39 offen offset:3072 sc1
  v_mfma_f32_16x16x32_bf16 v[22:25], v[224:227], v[212:215], v[22:25]
  v_mfma_f32_16x16x32_bf16 v[34:37], v[224:227], v[216:219], v[34:37]
  buffer_load_dwordx4 v[136:139], v3, s[8:11], s39 offen offset:0 sc1
  s_waitcnt vmcnt(12)
  v_mfma_f32_16x16x32_bf16 v[42:45], v[228:231], v[212:215], v[42:45]
  buffer_load_dwordx4 v[140:143], v3, s[8:11], s39 offen offset:1024 sc1
  v_mfma_f32_16x16x32_bf16 v[54:57], v[228:231], v[216:219], v[54:57]
  s_waitcnt vmcnt(12)
  v_mfma_f32_16x16x32_bf16 v[46:49], v[232:235], v[212:215], v[46:49]
  buffer_load_dwordx4 v[144:147], v3, s[8:11], s39 offen offset:2048 sc1
  v_mfma_f32_16x16x32_bf16 v[58:61], v[232:235], v[216:219], v[58:61]
  buffer_load_dwordx4 v[148:151], v3, s[8:11], s39 offen offset:3072 sc1
  s_waitcnt vmcnt(13)
  v_mfma_f32_16x16x32_bf16 v[66:69], v[236:239], v[212:215], v[66:69]
  v_mfma_f32_16x16x32_bf16 v[78:81], v[236:239], v[216:219], v[78:81]
  s_waitcnt vmcnt(12)
  v_mfma_f32_16x16x32_bf16 v[70:73], v[240:243], v[212:215], v[70:73]
  v_mfma_f32_16x16x32_bf16 v[82:85], v[240:243], v[216:219], v[82:85]
  s_waitcnt vmcnt(11)
  v_mfma_f32_16x16x32_bf16 v[90:93], v[244:247], v[212:215], v[90:93]
  v_mfma_f32_16x16x32_bf16 v[102:105], v[244:247], v[216:219], v[102:105]
  s_waitcnt vmcnt(10)
  v_mfma_f32_16x16x32_bf16 v[94:97], v[248:251], v[212:215], v[94:97]
  v_mfma_f32_16x16x32_bf16 v[106:109], v[248:251], v[216:219], v[106:109]
  v_mov_b32 v207, 147456
  s_cmp_lg_u32 s3, 0
  s_cbranch_scc1 P2_nochk
  s_waitcnt vmcnt(10)

  v_xor_b32 v208, v208, v200
  v_xor_b32 v209, v209, v201
  v_xor_b32 v210, v210, v200
  v_xor_b32 v211, v211, v201
  v_or_b32 v208, v208, v209
  v_or_b32 v210, v210, v211
  v_cmp_ne_u32 vcc, 0, v208
  v_cmp_ne_u32 s[44:45], 0, v210
  s_nop 3
  s_and_b32 s45, s45, 0x3f
  s_or_b64 vcc, vcc, s[44:45]
  s_and_b32 vcc_lo, vcc_lo, s42
  s_and_b32 vcc_hi, vcc_hi, 0x7f
  s_cmp_eq_u64 vcc, 0

  s_cselect_b32 s40, 1, 0
  v_mov_b32 v208, s40
  ds_write_b32 v207, v208
  s_waitcnt lgkmcnt(0)

P2_nochk:
  s_barrier
  ds_read_b32 v208, v207
  s_waitcnt lgkmcnt(0)
  v_readfirstlane_b32 s40, v208

  s_nop 3
  s_cmp_eq_u32 s40, 1
  s_cbranch_scc1 P2_fast

  s_waitcnt vmcnt(8)
  v_mfma_f32_16x16x32_bf16 v[18:21], v[120:123], v[112:115], v[18:21]
  s_waitcnt vmcnt(6)
  v_mfma_f32_16x16x32_bf16 v[30:33], v[120:123], v[116:119], v[30:33]
  v_mfma_f32_16x16x32_bf16 v[22:25], v[124:127], v[112:115], v[22:25]
  v_mfma_f32_16x16x32_bf16 v[34:37], v[124:127], v[116:119], v[34:37]
  s_waitcnt vmcnt(5)
  v_mfma_f32_16x16x32_bf16 v[42:45], v[128:131], v[112:115], v[42:45]
  v_mfma_f32_16x16x32_bf16 v[54:57], v[128:131], v[116:119], v[54:57]
  s_waitcnt vmcnt(4)
  v_mfma_f32_16x16x32_bf16 v[46:49], v[132:135], v[112:115], v[46:49]
  v_mfma_f32_16x16x32_bf16 v[58:61], v[132:135], v[116:119], v[58:61]
  s_waitcnt vmcnt(3)
  v_mfma_f32_16x16x32_bf16 v[66:69], v[136:139], v[112:115], v[66:69]
  v_mfma_f32_16x16x32_bf16 v[78:81], v[136:139], v[116:119], v[78:81]
  s_waitcnt vmcnt(2)
  v_mfma_f32_16x16x32_bf16 v[70:73], v[140:143], v[112:115], v[70:73]
  v_mfma_f32_16x16x32_bf16 v[82:85], v[140:143], v[116:119], v[82:85]
  s_waitcnt vmcnt(1)
  v_mfma_f32_16x16x32_bf16 v[90:93], v[144:147], v[112:115], v[90:93]
  v_mfma_f32_16x16x32_bf16 v[102:105], v[144:147], v[116:119], v[102:105]
  s_waitcnt vmcnt(0)
  v_mfma_f32_16x16x32_bf16 v[94:97], v[148:151], v[112:115], v[94:97]
  v_mfma_f32_16x16x32_bf16 v[106:109], v[148:151], v[116:119], v[106:109]
  s_mov_b32 s40, 0
  s_cmp_lg_u32 s3, 0
  s_cbranch_scc1 P2_w2
P2_poll2:
  s_mov_b32 exec_lo, s42
  s_mov_b32 exec_hi, 0x7f
  buffer_load_dwordx4 v[208:211], v206, s[8:11], s41 offen sc1
  s_mov_b64 exec, -1

  s_waitcnt vmcnt(0)
  v_xor_b32 v208, v208, v200
  v_xor_b32 v209, v209, v201
  v_xor_b32 v210, v210, v200
  v_xor_b32 v211, v211, v201
  v_or_b32 v208, v208, v209
  v_or_b32 v210, v210, v211
  v_cmp_ne_u32 vcc, 0, v208
  v_cmp_ne_u32 s[44:45], 0, v210
  s_nop 3
  s_and_b32 s45, s45, 0x3f
  s_or_b64 vcc, vcc, s[44:45]
  s_and_b32 vcc_lo, vcc_lo, s42
  s_and_b32 vcc_hi, vcc_hi, 0x7f
  s_cmp_eq_u64 vcc, 0

  s_cbranch_scc1 P2_w2
  s_add_u32 s40, s40, 1
  s_cmp_ge_u32 s40, 0x40000
  s_cbranch_scc1 P2_w2
  s_sleep 4
  s_branch P2_poll2

P2_w2:
  s_barrier
  s_add_u32 s38, s34, 0
  buffer_load_dwordx4 v[208:211], v2, s[8:11], s38 offen sc1
  s_add_u32 s39, s32, 0
  buffer_load_dwordx4 v[160:163], v6, s[8:11], s39 offen offset:0 sc1
  buffer_load_dwordx4 v[164:167], v6, s[8:11], s39 offen offset:1024 sc1
  buffer_load_dwordx4 v[168:171], v2, s[8:11], s39 offen offset:2048 sc1
  buffer_load_dwordx4 v[172:175], v2, s[8:11], s39 offen offset:3072 sc1
  buffer_load_dwordx4 v[176:179], v3, s[8:11], s39 offen offset:0 sc1
  buffer_load_dwordx4 v[180:183], v3, s[8:11], s39 offen offset:1024 sc1
  buffer_load_dwordx4 v[184:187], v3, s[8:11], s39 offen offset:2048 sc1
  buffer_load_dwordx4 v[188:191], v3, s[8:11], s39 offen offset:3072 sc1
  s_add_u32 s38, s34, 6144
  buffer_load_dwordx4 v[212:215], v2, s[8:11], s38 offen sc1
  buffer_load_dwordx4 v[192:195], v4, s[8:11], s39 offen offset:0 sc1
  buffer_load_dwordx4 v[196:199], v4, s[8:11], s39 offen offset:1024 sc1
  s_add_u32 s38, s34, 12288
  buffer_load_dwordx4 v[216:219], v2, s[8:11], s38 offen sc1
  buffer_load_dwordx4 v[200:203], v7, s[8:11], s39 offen offset:0 sc1
  buffer_load_dwordx4 v[204:207], v7, s[8:11], s39 offen offset:1024 sc1
  s_add_u32 s38, s34, 2048
  buffer_load_dwordx4 v[220:223], v2, s[8:11], s38 offen sc1
  s_add_u32 s38, s34, 8192
  buffer_load_dwordx4 v[224:227], v2, s[8:11], s38 offen sc1
  s_add_u32 s38, s34, 14336
  buffer_load_dwordx4 v[228:231], v2, s[8:11], s38 offen sc1
  s_branch P2_conv
P2_fast:
  s_add_u32 s38, s34, 0
  buffer_load_dwordx4 v[208:211], v2, s[8:11], s38 offen sc1
  s_add_u32 s39, s32, 0
  buffer_load_dwordx4 v[160:163], v6, s[8:11], s39 offen offset:0 sc1
  buffer_load_dwordx4 v[164:167], v6, s[8:11], s39 offen offset:1024 sc1
  buffer_load_dwordx4 v[168:171], v2, s[8:11], s39 offen offset:2048 sc1
  buffer_load_dwordx4 v[172:175], v2, s[8:11], s39 offen offset:3072 sc1
  buffer_load_dwordx4 v[176:179], v3, s[8:11], s39 offen offset:0 sc1
  buffer_load_dwordx4 v[180:183], v3, s[8:11], s39 offen offset:1024 sc1
  buffer_load_dwordx4 v[184:187], v3, s[8:11], s39 offen offset:2048 sc1
  buffer_load_dwordx4 v[188:191], v3, s[8:11], s39 offen offset:3072 sc1
  s_add_u32 s38, s34, 6144
  buffer_load_dwordx4 v[212:215], v2, s[8:11], s38 offen sc1
  buffer_load_dwordx4 v[192:195], v4, s[8:11], s39 offen offset:0 sc1
  buffer_load_dwordx4 v[196:199], v4, s[8:11], s39 offen offset:1024 sc1
  s_add_u32 s38, s34, 12288
  buffer_load_dwordx4 v[216:219], v2, s[8:11], s38 offen sc1
  buffer_load_dwordx4 v[200:203], v7, s[8:11], s39 offen offset:0 sc1
  buffer_load_dwordx4 v[204:207], v7, s[8:11], s39 offen offset:1024 sc1
  s_add_u32 s38, s34, 2048
  buffer_load_dwordx4 v[220:223], v2, s[8:11], s38 offen sc1
  s_add_u32 s38, s34, 8192
  buffer_load_dwordx4 v[224:227], v2, s[8:11], s38 offen sc1
  s_add_u32 s38, s34, 14336
  buffer_load_dwordx4 v[228:231], v2, s[8:11], s38 offen sc1
  s_waitcnt vmcnt(26)
  v_mfma_f32_16x16x32_bf16 v[18:21], v[120:123], v[112:115], v[18:21]
  s_waitcnt vmcnt(24)
  v_mfma_f32_16x16x32_bf16 v[30:33], v[120:123], v[116:119], v[30:33]
  v_mfma_f32_16x16x32_bf16 v[22:25], v[124:127], v[112:115], v[22:25]
  v_mfma_f32_16x16x32_bf16 v[34:37], v[124:127], v[116:119], v[34:37]
  s_waitcnt vmcnt(23)
  v_mfma_f32_16x16x32_bf16 v[42:45], v[128:131], v[112:115], v[42:45]
  v_mfma_f32_16x16x32_bf16 v[54:57], v[128:131], v[116:119], v[54:57]
  s_waitcnt vmcnt(22)
  v_mfma_f32_16x16x32_bf16 v[46:49], v[132:135], v[112:115], v[46:49]
  v_mfma_f32_16x16x32_bf16 v[58:61], v[132:135], v[116:119], v[58:61]
  s_waitcnt vmcnt(21)
  v_mfma_f32_16x16x32_bf16 v[66:69], v[136:139], v[112:115], v[66:69]
  v_mfma_f32_16x16x32_bf16 v[78:81], v[136:139], v[116:119], v[78:81]
  s_waitcnt vmcnt(20)
  v_mfma_f32_16x16x32_bf16 v[70:73], v[140:143], v[112:115], v[70:73]
  v_mfma_f32_16x16x32_bf16 v[82:85], v[140:143], v[116:119], v[82:85]
  s_waitcnt vmcnt(19)
  v_mfma_f32_16x16x32_bf16 v[90:93], v[144:147], v[112:115], v[90:93]
  v_mfma_f32_16x16x32_bf16 v[102:105], v[144:147], v[116:119], v[102:105]
  s_waitcnt vmcnt(18)
  v_mfma_f32_16x16x32_bf16 v[94:97], v[148:151], v[112:115], v[94:97]
  v_mfma_f32_16x16x32_bf16 v[106:109], v[148:151], v[116:119], v[106:109]
  s_nop 7
P2_conv:
  s_waitcnt vmcnt(16)
  v_mfma_f32_16x16x32_bf16 v[20:23], v[160:163], v[208:211], v[20:23]
  s_add_u32 s38, s34, 4096
  buffer_load_dwordx4 v[232:235], v2, s[8:11], s38 offen sc1
  s_waitcnt vmcnt(16)
  v_mfma_f32_16x16x32_bf16 v[24:27], v[164:167], v[208:211], v[24:27]
  s_waitcnt vmcnt(15)
  v_mfma_f32_16x16x32_bf16 v[44:47], v[168:171], v[208:211], v[44:47]
  s_waitcnt vmcnt(14)
  v_mfma_f32_16x16x32_bf16 v[48:51], v[172:175], v[208:211], v[48:51]
  s_waitcnt vmcnt(13)
  v_mfma_f32_16x16x32_bf16 v[68:71], v[176:179], v[208:211], v[68:71]
  s_add_u32 s38, s34, 10240
  buffer_load_dwordx4 v[236:239], v2, s[8:11], s38 offen sc1
  s_waitcnt vmcnt(13)
  v_mfma_f32_16x16x32_bf16 v[72:75], v[180:183], v[208:211], v[72:75]
  s_waitcnt vmcnt(12)
  v_mfma_f32_16x16x32_bf16 v[92:95], v[184:187], v[208:211], v[92:95]
  s_waitcnt vmcnt(11)
  v_mfma_f32_16x16x32_bf16 v[96:99], v[188:191], v[208:211], v[96:99]
  s_waitcnt vmcnt(10)
  v_mfma_f32_16x16x32_bf16 v[20:23], v[168:171], v[212:215], v[20:23]
  s_add_u32 s38, s34, 16384
  buffer_load_dwordx4 v[240:243], v2, s[8:11], s38 offen sc1
  v_mfma_f32_16x16x32_bf16 v[24:27], v[172:175], v[212:215], v[24:27]
  v_mfma_f32_16x16x32_bf16 v[44:47], v[176:179], v[212:215], v[44:47]
  s_add_u32 s39, s32, 131072
  buffer_load_dwordx4 v[112:115], v6, s[8:11], s39 offen offset:0 sc1
  v_mfma_f32_16x16x32_bf16 v[48:51], v[180:183], v[212:215], v[48:51]
  v_mfma_f32_16x16x32_bf16 v[68:71], v[184:187], v[212:215], v[68:71]
  s_add_u32 s38, s34, 1024
  buffer_load_dwordx4 v[244:247], v2, s[8:11], s38 offen sc1
  v_mfma_f32_16x16x32_bf16 v[72:75], v[188:191], v[212:215], v[72:75]
  s_waitcnt vmcnt(12)
  v_mfma_f32_16x16x32_bf16 v[92:95], v[192:195], v[212:215], v[92:95]
  s_waitcnt vmcnt(11)
  v_mfma_f32_16x16x32_bf16 v[96:99], v[196:199], v[212:215], v[96:99]
  s_waitcnt vmcnt(10)
  v_mfma_f32_16x16x32_bf16 v[20:23], v[176:179], v[216:219], v[20:23]
  s_add_u32 s38, s34, 7168
  buffer_load_dwordx4 v[248:251], v2, s[8:11], s38 offen sc1
  v_mfma_f32_16x16x32_bf16 v[24:27], v[180:183], v[216:219], v[24:27]
  v_mfma_f32_16x16x32_bf16 v[44:47], v[184:187], v[216:219], v[44:47]
  buffer_load_dwordx4 v[116:119], v6, s[8:11], s39 offen offset:1024 sc1
  v_mfma_f32_16x16x32_bf16 v[48:51], v[188:191], v[216:219], v[48:51]
  v_mfma_f32_16x16x32_bf16 v[68:71], v[192:195], v[216:219], v[68:71]
  s_add_u32 s38, s34, 13312
  buffer_load_dwordx4 v[252:255], v2, s[8:11], s38 offen sc1
  v_mfma_f32_16x16x32_bf16 v[72:75], v[196:199], v[216:219], v[72:75]
  s_waitcnt vmcnt(12)
  v_mfma_f32_16x16x32_bf16 v[92:95], v[200:203], v[216:219], v[92:95]
  s_waitcnt vmcnt(11)
  v_mfma_f32_16x16x32_bf16 v[96:99], v[204:207], v[216:219], v[96:99]
  s_waitcnt vmcnt(10)
  v_mfma_f32_16x16x32_bf16 v[18:21], v[160:163], v[220:223], v[18:21]
  s_add_u32 s38, s34, 3072
  buffer_load_dwordx4 v[208:211], v2, s[8:11], s38 offen sc1
  v_mfma_f32_16x16x32_bf16 v[22:25], v[164:167], v[220:223], v[22:25]
  v_mfma_f32_16x16x32_bf16 v[42:45], v[168:171], v[220:223], v[42:45]
  buffer_load_dwordx4 v[120:123], v2, s[8:11], s39 offen offset:2048 sc1
  v_mfma_f32_16x16x32_bf16 v[46:49], v[172:175], v[220:223], v[46:49]
  v_mfma_f32_16x16x32_bf16 v[66:69], v[176:179], v[220:223], v[66:69]
  s_add_u32 s38, s34, 9216
  buffer_load_dwordx4 v[212:215], v2, s[8:11], s38 offen sc1
  v_mfma_f32_16x16x32_bf16 v[70:73], v[180:183], v[220:223], v[70:73]
  v_mfma_f32_16x16x32_bf16 v[90:93], v[184:187], v[220:223], v[90:93]
  v_mfma_f32_16x16x32_bf16 v[94:97], v[188:191], v[220:223], v[94:97]
  s_waitcnt vmcnt(12)
  v_mfma_f32_16x16x32_bf16 v[18:21], v[168:171], v[224:227], v[18:21]
  s_add_u32 s38, s34, 15360
  buffer_load_dwordx4 v[216:219], v2, s[8:11], s38 offen sc1
  v_mfma_f32_16x16x32_bf16 v[22:25], v[172:175], v[224:227], v[22:25]
  v_mfma_f32_16x16x32_bf16 v[42:45], v[176:179], v[224:227], v[42:45]
  buffer_load_dwordx4 v[124:127], v2, s[8:11], s39 offen offset:3072 sc1
  v_mfma_f32_16x16x32_bf16 v[46:49], v[180:183], v[224:227], v[46:49]
  v_mfma_f32_16x16x32_bf16 v[66:69], v[184:187], v[224:227], v[66:69]
  s_add_u32 s38, s34, 5120
  buffer_load_dwordx4 v[220:223], v2, s[8:11], s38 offen sc1
  v_mfma_f32_16x16x32_bf16 v[70:73], v[188:191], v[224:227], v[70:73]
  v_mfma_f32_16x16x32_bf16 v[90:93], v[192:195], v[224:227], v[90:93]
  v_mfma_f32_16x16x32_bf16 v[94:97], v[196:199], v[224:227], v[94:97]
  s_waitcnt vmcnt(14)
  v_mfma_f32_16x16x32_bf16 v[18:21], v[176:179], v[228:231], v[18:21]
  s_add_u32 s38, s34, 11264
  buffer_load_dwordx4 v[224:227], v2, s[8:11], s38 offen sc1
  v_mfma_f32_16x16x32_bf16 v[22:25], v[180:183], v[228:231], v[22:25]
  v_mfma_f32_16x16x32_bf16 v[42:45], v[184:187], v[228:231], v[42:45]
  buffer_load_dwordx4 v[128:131], v3, s[8:11], s39 offen offset:0 sc1
  v_mfma_f32_16x16x32_bf16 v[46:49], v[188:191], v[228:231], v[46:49]
  v_mfma_f32_16x16x32_bf16 v[66:69], v[192:195], v[228:231], v[66:69]
  v_mfma_f32_16x16x32_bf16 v[70:73], v[196:199], v[228:231], v[70:73]
  v_mfma_f32_16x16x32_bf16 v[90:93], v[200:203], v[228:231], v[90:93]
  v_mfma_f32_16x16x32_bf16 v[94:97], v[204:207], v[228:231], v[94:97]
  s_waitcnt vmcnt(15)
  v_mfma_f32_16x16x32_bf16 v[16:19], v[160:163], v[232:235], v[16:19]
  s_add_u32 s38, s34, 17408
  buffer_load_dwordx4 v[228:231], v2, s[8:11], s38 offen sc1
  v_mfma_f32_16x16x32_bf16 v[20:23], v[164:167], v[232:235], v[20:23]
  v_mfma_f32_16x16x32_bf16 v[40:43], v[168:171], v[232:235], v[40:43]
  buffer_load_dwordx4 v[132:135], v3, s[8:11], s39 offen offset:1024 sc1
  v_mfma_f32_16x16x32_bf16 v[44:47], v[172:175], v[232:235], v[44:47]
  v_mfma_f32_16x16x32_bf16 v[64:67], v[176:179], v[232:235], v[64:67]
  v_mfma_f32_16x16x32_bf16 v[68:71], v[180:183], v[232:235], v[68:71]
  v_mfma_f32_16x16x32_bf16 v[88:91], v[184:187], v[232:235], v[88:91]
  v_mfma_f32_16x16x32_bf16 v[92:95], v[188:191], v[232:235], v[92:95]
  s_waitcnt vmcnt(16)
  v_mfma_f32_16x16x32_bf16 v[16:19], v[168:171], v[236:239], v[16:19]
  s_add_u32 s38, s34, 20480
  buffer_load_dwordx4 v[232:235], v2, s[8:11], s38 offen sc1
  v_mfma_f32_16x16x32_bf16 v[20:23], v[172:175], v[236:239], v[20:23]
  v_mfma_f32_16x16x32_bf16 v[40:43], v[176:179], v[236:239], v[40:43]
  buffer_load_dwordx4 v[136:139], v3, s[8:11], s39 offen offset:2048 sc1
  v_mfma_f32_16x16x32_bf16 v[44:47], v[180:183], v[236:239], v[44:47]
  v_mfma_f32_16x16x32_bf16 v[64:67], v[184:187], v[236:239], v[64:67]
  v_mfma_f32_16x16x32_bf16 v[68:71], v[188:191], v[236:239], v[68:71]
  v_mfma_f32_16x16x32_bf16 v[88:91], v[192:195], v[236:239], v[88:91]
  v_mfma_f32_16x16x32_bf16 v[92:95], v[196:199], v[236:239], v[92:95]
  s_waitcnt vmcnt(17)
  v_mfma_f32_16x16x32_bf16 v[16:19], v[176:179], v[240:243], v[16:19]
  s_add_u32 s38, s34, 26624
  buffer_load_dwordx4 v[236:239], v2, s[8:11], s38 offen sc1
  v_mfma_f32_16x16x32_bf16 v[20:23], v[180:183], v[240:243], v[20:23]
  v_mfma_f32_16x16x32_bf16 v[40:43], v[184:187], v[240:243], v[40:43]
  buffer_load_dwordx4 v[140:143], v3, s[8:11], s39 offen offset:3072 sc1
  v_mfma_f32_16x16x32_bf16 v[44:47], v[188:191], v[240:243], v[44:47]
  v_mfma_f32_16x16x32_bf16 v[64:67], v[192:195], v[240:243], v[64:67]
  v_mfma_f32_16x16x32_bf16 v[68:71], v[196:199], v[240:243], v[68:71]
  v_mfma_f32_16x16x32_bf16 v[88:91], v[200:203], v[240:243], v[88:91]
  v_mfma_f32_16x16x32_bf16 v[92:95], v[204:207], v[240:243], v[92:95]
  s_waitcnt vmcnt(17)
  v_mfma_f32_16x16x32_bf16 v[32:35], v[160:163], v[244:247], v[32:35]
  s_add_u32 s38, s34, 32768
  buffer_load_dwordx4 v[240:243], v2, s[8:11], s38 offen sc1
  v_mfma_f32_16x16x32_bf16 v[36:39], v[164:167], v[244:247], v[36:39]
  v_mfma_f32_16x16x32_bf16 v[56:59], v[168:171], v[244:247], v[56:59]
  buffer_load_dwordx4 v[144:147], v4, s[8:11], s39 offen offset:0 sc1
  v_mfma_f32_16x16x32_bf16 v[60:63], v[172:175], v[244:247], v[60:63]
  v_mfma_f32_16x16x32_bf16 v[80:83], v[176:179], v[244:247], v[80:83]
  v_mfma_f32_16x16x32_bf16 v[84:87], v[180:183], v[244:247], v[84:87]
  v_mfma_f32_16x16x32_bf16 v[104:107], v[184:187], v[244:247], v[104:107]
  v_mfma_f32_16x16x32_bf16 v[108:111], v[188:191], v[244:247], v[108:111]
  s_waitcnt vmcnt(18)
  v_mfma_f32_16x16x32_bf16 v[32:35], v[168:171], v[248:251], v[32:35]
  s_add_u32 s38, s34, 22528
  buffer_load_dwordx4 v[244:247], v2, s[8:11], s38 offen sc1
  v_mfma_f32_16x16x32_bf16 v[36:39], v[172:175], v[248:251], v[36:39]
  v_mfma_f32_16x16x32_bf16 v[56:59], v[176:179], v[248:251], v[56:59]
  buffer_load_dwordx4 v[148:151], v4, s[8:11], s39 offen offset:1024 sc1
  v_mfma_f32_16x16x32_bf16 v[60:63], v[180:183], v[248:251], v[60:63]
  v_mfma_f32_16x16x32_bf16 v[80:83], v[184:187], v[248:251], v[80:83]
  v_mfma_f32_16x16x32_bf16 v[84:87], v[188:191], v[248:251], v[84:87]
  v_mfma_f32_16x16x32_bf16 v[104:107], v[192:195], v[248:251], v[104:107]
  v_mfma_f32_16x16x32_bf16 v[108:111], v[196:199], v[248:251], v[108:111]
  s_waitcnt vmcnt(18)
  v_mfma_f32_16x16x32_bf16 v[32:35], v[176:179], v[252:255], v[32:35]
  s_add_u32 s38, s34, 28672
  buffer_load_dwordx4 v[248:251], v2, s[8:11], s38 offen sc1
  v_mfma_f32_16x16x32_bf16 v[36:39], v[180:183], v[252:255], v[36:39]
  v_mfma_f32_16x16x32_bf16 v[56:59], v[184:187], v[252:255], v[56:59]
  buffer_load_dwordx4 v[152:155], v7, s[8:11], s39 offen offset:0 sc1
  v_mfma_f32_16x16x32_bf16 v[60:63], v[188:191], v[252:255], v[60:63]
  v_mfma_f32_16x16x32_bf16 v[80:83], v[192:195], v[252:255], v[80:83]
  v_mfma_f32_16x16x32_bf16 v[84:87], v[196:199], v[252:255], v[84:87]
  v_mfma_f32_16x16x32_bf16 v[104:107], v[200:203], v[252:255], v[104:107]
  v_mfma_f32_16x16x32_bf16 v[108:111], v[204:207], v[252:255], v[108:111]
  s_waitcnt vmcnt(19)
  v_mfma_f32_16x16x32_bf16 v[30:33], v[160:163], v[208:211], v[30:33]
  s_add_u32 s38, s34, 34816
  buffer_load_dwordx4 v[252:255], v2, s[8:11], s38 offen sc1
  v_mfma_f32_16x16x32_bf16 v[34:37], v[164:167], v[208:211], v[34:37]
  v_mfma_f32_16x16x32_bf16 v[54:57], v[168:171], v[208:211], v[54:57]
  buffer_load_dwordx4 v[156:159], v7, s[8:11], s39 offen offset:1024 sc1
  v_mfma_f32_16x16x32_bf16 v[58:61], v[172:175], v[208:211], v[58:61]
  v_mfma_f32_16x16x32_bf16 v[78:81], v[176:179], v[208:211], v[78:81]
  v_mfma_f32_16x16x32_bf16 v[82:85], v[180:183], v[208:211], v[82:85]
  v_mfma_f32_16x16x32_bf16 v[102:105], v[184:187], v[208:211], v[102:105]
  v_mfma_f32_16x16x32_bf16 v[106:109], v[188:191], v[208:211], v[106:109]
  s_waitcnt vmcnt(19)
  v_mfma_f32_16x16x32_bf16 v[30:33], v[168:171], v[212:215], v[30:33]
  s_add_u32 s38, s34, 24576
  buffer_load_dwordx4 v[208:211], v2, s[8:11], s38 offen sc1
  v_mfma_f32_16x16x32_bf16 v[34:37], v[172:175], v[212:215], v[34:37]
  v_mfma_f32_16x16x32_bf16 v[54:57], v[176:179], v[212:215], v[54:57]
  v_mfma_f32_16x16x32_bf16 v[58:61], v[180:183], v[212:215], v[58:61]
  v_mfma_f32_16x16x32_bf16 v[78:81], v[184:187], v[212:215], v[78:81]
  v_mfma_f32_16x16x32_bf16 v[82:85], v[188:191], v[212:215], v[82:85]
  v_mfma_f32_16x16x32_bf16 v[102:105], v[192:195], v[212:215], v[102:105]
  v_mfma_f32_16x16x32_bf16 v[106:109], v[196:199], v[212:215], v[106:109]
  s_waitcnt vmcnt(19)
  v_mfma_f32_16x16x32_bf16 v[30:33], v[176:179], v[216:219], v[30:33]
  s_add_u32 s38, s34, 30720
  buffer_load_dwordx4 v[212:215], v2, s[8:11], s38 offen sc1
  v_mfma_f32_16x16x32_bf16 v[34:37], v[180:183], v[216:219], v[34:37]
  v_mfma_f32_16x16x32_bf16 v[54:57], v[184:187], v[216:219], v[54:57]
  v_mfma_f32_16x16x32_bf16 v[58:61], v[188:191], v[216:219], v[58:61]
  v_mfma_f32_16x16x32_bf16 v[78:81], v[192:195], v[216:219], v[78:81]
  v_mfma_f32_16x16x32_bf16 v[82:85], v[196:199], v[216:219], v[82:85]
  v_mfma_f32_16x16x32_bf16 v[102:105], v[200:203], v[216:219], v[102:105]
  v_mfma_f32_16x16x32_bf16 v[106:109], v[204:207], v[216:219], v[106:109]
  s_waitcnt vmcnt(18)
  v_mfma_f32_16x16x32_bf16 v[28:31], v[160:163], v[220:223], v[28:31]
  s_add_u32 s38, s34, 36864
  buffer_load_dwordx4 v[216:219], v2, s[8:11], s38 offen sc1
  v_mfma_f32_16x16x32_bf16 v[32:35], v[164:167], v[220:223], v[32:35]
  v_mfma_f32_16x16x32_bf16 v[52:55], v[168:171], v[220:223], v[52:55]
  v_mfma_f32_16x16x32_bf16 v[56:59], v[172:175], v[220:223], v[56:59]
  v_mfma_f32_16x16x32_bf16 v[76:79], v[176:179], v[220:223], v[76:79]
  v_mfma_f32_16x16x32_bf16 v[80:83], v[180:183], v[220:223], v[80:83]
  v_mfma_f32_16x16x32_bf16 v[100:103], v[184:187], v[220:223], v[100:103]
  v_mfma_f32_16x16x32_bf16 v[104:107], v[188:191], v[220:223], v[104:107]
  s_waitcnt vmcnt(18)
  v_mfma_f32_16x16x32_bf16 v[28:31], v[168:171], v[224:227], v[28:31]
  s_add_u32 s38, s34, 21504
  buffer_load_dwordx4 v[220:223], v2, s[8:11], s38 offen sc1
  v_mfma_f32_16x16x32_bf16 v[32:35], v[172:175], v[224:227], v[32:35]
  v_mfma_f32_16x16x32_bf16 v[52:55], v[176:179], v[224:227], v[52:55]
  v_mfma_f32_16x16x32_bf16 v[56:59], v[180:183], v[224:227], v[56:59]
  v_mfma_f32_16x16x32_bf16 v[76:79], v[184:187], v[224:227], v[76:79]
  v_mfma_f32_16x16x32_bf16 v[80:83], v[188:191], v[224:227], v[80:83]
  v_mfma_f32_16x16x32_bf16 v[100:103], v[192:195], v[224:227], v[100:103]
  v_mfma_f32_16x16x32_bf16 v[104:107], v[196:199], v[224:227], v[104:107]
  s_waitcnt vmcnt(17)
  v_mfma_f32_16x16x32_bf16 v[28:31], v[176:179], v[228:231], v[28:31]
  s_add_u32 s38, s34, 27648
  buffer_load_dwordx4 v[224:227], v2, s[8:11], s38 offen sc1
  v_mfma_f32_16x16x32_bf16 v[32:35], v[180:183], v[228:231], v[32:35]
  v_mfma_f32_16x16x32_bf16 v[52:55], v[184:187], v[228:231], v[52:55]
  v_mfma_f32_16x16x32_bf16 v[56:59], v[188:191], v[228:231], v[56:59]
  v_mfma_f32_16x16x32_bf16 v[76:79], v[192:195], v[228:231], v[76:79]
  v_mfma_f32_16x16x32_bf16 v[80:83], v[196:199], v[228:231], v[80:83]
  v_mfma_f32_16x16x32_bf16 v[100:103], v[200:203], v[228:231], v[100:103]
  v_mfma_f32_16x16x32_bf16 v[104:107], v[204:207], v[228:231], v[104:107]
  s_waitcnt vmcnt(16)
  v_mfma_f32_16x16x32_bf16 v[20:23], v[112:115], v[232:235], v[20:23]
  s_add_u32 s38, s34, 33792
  buffer_load_dwordx4 v[228:231], v2, s[8:11], s38 offen sc1
  v_mfma_f32_16x16x32_bf16 v[24:27], v[116:119], v[232:235], v[24:27]
  v_mfma_f32_16x16x32_bf16 v[44:47], v[120:123], v[232:235], v[44:47]
  v_mfma_f32_16x16x32_bf16 v[48:51], v[124:127], v[232:235], v[48:51]
  v_mfma_f32_16x16x32_bf16 v[68:71], v[128:131], v[232:235], v[68:71]
  v_mfma_f32_16x16x32_bf16 v[72:75], v[132:135], v[232:235], v[72:75]
  s_waitcnt vmcnt(16)
  v_mfma_f32_16x16x32_bf16 v[92:95], v[136:139], v[232:235], v[92:95]
  s_waitcnt vmcnt(14)
  v_mfma_f32_16x16x32_bf16 v[96:99], v[140:143], v[232:235], v[96:99]
  v_mfma_f32_16x16x32_bf16 v[20:23], v[120:123], v[236:239], v[20:23]
  s_add_u32 s38, s34, 23552
  buffer_load_dwordx4 v[232:235], v2, s[8:11], s38 offen sc1
  v_mfma_f32_16x16x32_bf16 v[24:27], v[124:127], v[236:239], v[24:27]
  v_mfma_f32_16x16x32_bf16 v[44:47], v[128:131], v[236:239], v[44:47]
  s_add_u32 s39, s32, 262144
  buffer_load_dwordx4 v[160:163], v6, s[8:11], s39 offen offset:0 sc1
  v_mfma_f32_16x16x32_bf16 v[48:51], v[132:135], v[236:239], v[48:51]
  v_mfma_f32_16x16x32_bf16 v[68:71], v[136:139], v[236:239], v[68:71]
  v_mfma_f32_16x16x32_bf16 v[72:75], v[140:143], v[236:239], v[72:75]
  s_waitcnt vmcnt(14)
  v_mfma_f32_16x16x32_bf16 v[92:95], v[144:147], v[236:239], v[92:95]
  s_waitcnt vmcnt(12)
  v_mfma_f32_16x16x32_bf16 v[96:99], v[148:151], v[236:239], v[96:99]
  v_mfma_f32_16x16x32_bf16 v[20:23], v[128:131], v[240:243], v[20:23]
  s_add_u32 s38, s34, 29696
  buffer_load_dwordx4 v[236:239], v2, s[8:11], s38 offen sc1
  v_mfma_f32_16x16x32_bf16 v[24:27], v[132:135], v[240:243], v[24:27]
  v_mfma_f32_16x16x32_bf16 v[44:47], v[136:139], v[240:243], v[44:47]
  buffer_load_dwordx4 v[164:167], v6, s[8:11], s39 offen offset:1024 sc1
  v_mfma_f32_16x16x32_bf16 v[48:51], v[140:143], v[240:243], v[48:51]
  v_mfma_f32_16x16x32_bf16 v[68:71], v[144:147], v[240:243], v[68:71]
  v_mfma_f32_16x16x32_bf16 v[72:75], v[148:151], v[240:243], v[72:75]
  s_waitcnt vmcnt(12)
  v_mfma_f32_16x16x32_bf16 v[92:95], v[152:155], v[240:243], v[92:95]
  s_waitcnt vmcnt(10)
  v_mfma_f32_16x16x32_bf16 v[96:99], v[156:159], v[240:243], v[96:99]
  v_mfma_f32_16x16x32_bf16 v[18:21], v[112:115], v[244:247], v[18:21]
  s_add_u32 s38, s34, 35840
  buffer_load_dwordx4 v[240:243], v2, s[8:11], s38 offen sc1
  v_mfma_f32_16x16x32_bf16 v[22:25], v[116:119], v[244:247], v[22:25]
  v_mfma_f32_16x16x32_bf16 v[42:45], v[120:123], v[244:247], v[42:45]
  buffer_load_dwordx4 v[168:171], v2, s[8:11], s39 offen offset:2048 sc1
  v_mfma_f32_16x16x32_bf16 v[46:49], v[124:127], v[244:247], v[46:49]
  v_mfma_f32_16x16x32_bf16 v[66:69], v[128:131], v[244:247], v[66:69]
  v_mfma_f32_16x16x32_bf16 v[70:73], v[132:135], v[244:247], v[70:73]
  v_mfma_f32_16x16x32_bf16 v[90:93], v[136:139], v[244:247], v[90:93]
  v_mfma_f32_16x16x32_bf16 v[94:97], v[140:143], v[244:247], v[94:97]
  v_mfma_f32_16x16x32_bf16 v[18:21], v[120:123], v[248:251], v[18:21]
  s_add_u32 s38, s34, 25600
  buffer_load_dwordx4 v[244:247], v2, s[8:11], s38 offen sc1
  v_mfma_f32_16x16x32_bf16 v[22:25], v[124:127], v[248:251], v[22:25]
  v_mfma_f32_16x16x32_bf16 v[42:45], v[128:131], v[248:251], v[42:45]
  buffer_load_dwordx4 v[172:175], v2, s[8:11], s39 offen offset:3072 sc1
  v_mfma_f32_16x16x32_bf16 v[46:49], v[132:135], v[248:251], v[46:49]
  v_mfma_f32_16x16x32_bf16 v[66:69], v[136:139], v[248:251], v[66:69]
  v_mfma_f32_16x16x32_bf16 v[70:73], v[140:143], v[248:251], v[70:73]
  v_mfma_f32_16x16x32_bf16 v[90:93], v[144:147], v[248:251], v[90:93]
  v_mfma_f32_16x16x32_bf16 v[94:97], v[148:151], v[248:251], v[94:97]
  v_mfma_f32_16x16x32_bf16 v[18:21], v[128:131], v[252:255], v[18:21]
  s_add_u32 s38, s34, 31744
  buffer_load_dwordx4 v[248:251], v2, s[8:11], s38 offen sc1
  v_mfma_f32_16x16x32_bf16 v[22:25], v[132:135], v[252:255], v[22:25]
  v_mfma_f32_16x16x32_bf16 v[42:45], v[136:139], v[252:255], v[42:45]
  buffer_load_dwordx4 v[176:179], v3, s[8:11], s39 offen offset:0 sc1
  v_mfma_f32_16x16x32_bf16 v[46:49], v[140:143], v[252:255], v[46:49]
  v_mfma_f32_16x16x32_bf16 v[66:69], v[144:147], v[252:255], v[66:69]
  v_mfma_f32_16x16x32_bf16 v[70:73], v[148:151], v[252:255], v[70:73]
  v_mfma_f32_16x16x32_bf16 v[90:93], v[152:155], v[252:255], v[90:93]
  v_mfma_f32_16x16x32_bf16 v[94:97], v[156:159], v[252:255], v[94:97]
  s_waitcnt vmcnt(15)
  v_mfma_f32_16x16x32_bf16 v[16:19], v[112:115], v[208:211], v[16:19]
  s_add_u32 s38, s34, 37888
  buffer_load_dwordx4 v[252:255], v2, s[8:11], s38 offen sc1
  v_mfma_f32_16x16x32_bf16 v[20:23], v[116:119], v[208:211], v[20:23]
  v_mfma_f32_16x16x32_bf16 v[40:43], v[120:123], v[208:211], v[40:43]
  buffer_load_dwordx4 v[180:183], v3, s[8:11], s39 offen offset:1024 sc1
  v_mfma_f32_16x16x32_bf16 v[44:47], v[124:127], v[208:211], v[44:47]
  v_mfma_f32_16x16x32_bf16 v[64:67], v[128:131], v[208:211], v[64:67]
  v_mfma_f32_16x16x32_bf16 v[68:71], v[132:135], v[208:211], v[68:71]
  v_mfma_f32_16x16x32_bf16 v[88:91], v[136:139], v[208:211], v[88:91]
  v_mfma_f32_16x16x32_bf16 v[92:95], v[140:143], v[208:211], v[92:95]
  s_waitcnt vmcnt(16)
  v_mfma_f32_16x16x32_bf16 v[16:19], v[120:123], v[212:215], v[16:19]
  s_add_u32 s38, s34, 40960
  buffer_load_dwordx4 v[208:211], v2, s[8:11], s38 offen sc1
  v_mfma_f32_16x16x32_bf16 v[20:23], v[124:127], v[212:215], v[20:23]
  v_mfma_f32_16x16x32_bf16 v[40:43], v[128:131], v[212:215], v[40:43]
  buffer_load_dwordx4 v[184:187], v3, s[8:11], s39 offen offset:2048 sc1
  v_mfma_f32_16x16x32_bf16 v[44:47], v[132:135], v[212:215], v[44:47]
  v_mfma_f32_16x16x32_bf16 v[64:67], v[136:139], v[212:215], v[64:67]
  v_mfma_f32_16x16x32_bf16 v[68:71], v[140:143], v[212:215], v[68:71]
  v_mfma_f32_16x16x32_bf16 v[88:91], v[144:147], v[212:215], v[88:91]
  v_mfma_f32_16x16x32_bf16 v[92:95], v[148:151], v[212:215], v[92:95]
  s_waitcnt vmcnt(17)
  v_mfma_f32_16x16x32_bf16 v[16:19], v[128:131], v[216:219], v[16:19]
  s_add_u32 s38, s34, 47104
  buffer_load_dwordx4 v[212:215], v2, s[8:11], s38 offen sc1
  v_mfma_f32_16x16x32_bf16 v[20:23], v[132:135], v[216:219], v[20:23]
  v_mfma_f32_16x16x32_bf16 v[40:43], v[136:139], v[216:219], v[40:43]
  buffer_load_dwordx4 v[188:191], v3, s[8:11], s39 offen offset:3072 sc1
  v_mfma_f32_16x16x32_bf16 v[44:47], v[140:143], v[216:219], v[44:47]
  v_mfma_f32_16x16x32_bf16 v[64:67], v[144:147], v[216:219], v[64:67]
  v_mfma_f32_16x16x32_bf16 v[68:71], v[148:151], v[216:219], v[68:71]
  v_mfma_f32_16x16x32_bf16 v[88:91], v[152:155], v[216:219], v[88:91]
  v_mfma_f32_16x16x32_bf16 v[92:95], v[156:159], v[216:219], v[92:95]
  s_waitcnt vmcnt(18)
  v_mfma_f32_16x16x32_bf16 v[32:35], v[112:115], v[220:223], v[32:35]
  s_add_u32 s38, s34, 53248
  buffer_load_dwordx4 v[216:219], v2, s[8:11], s38 offen sc1
  v_mfma_f32_16x16x32_bf16 v[36:39], v[116:119], v[220:223], v[36:39]
  v_mfma_f32_16x16x32_bf16 v[56:59], v[120:123], v[220:223], v[56:59]
  buffer_load_dwordx4 v[192:195], v4, s[8:11], s39 offen offset:0 sc1
  v_mfma_f32_16x16x32_bf16 v[60:63], v[124:127], v[220:223], v[60:63]
  v_mfma_f32_16x16x32_bf16 v[80:83], v[128:131], v[220:223], v[80:83]
  v_mfma_f32_16x16x32_bf16 v[84:87], v[132:135], v[220:223], v[84:87]
  v_mfma_f32_16x16x32_bf16 v[104:107], v[136:139], v[220:223], v[104:107]
  v_mfma_f32_16x16x32_bf16 v[108:111], v[140:143], v[220:223], v[108:111]
  s_waitcnt vmcnt(19)
  v_mfma_f32_16x16x32_bf16 v[32:35], v[120:123], v[224:227], v[32:35]
  s_add_u32 s38, s34, 43008
  buffer_load_dwordx4 v[220:223], v2, s[8:11], s38 offen sc1
  v_mfma_f32_16x16x32_bf16 v[36:39], v[124:127], v[224:227], v[36:39]
  v_mfma_f32_16x16x32_bf16 v[56:59], v[128:131], v[224:227], v[56:59]
  buffer_load_dwordx4 v[196:199], v4, s[8:11], s39 offen offset:1024 sc1
  v_mfma_f32_16x16x32_bf16 v[60:63], v[132:135], v[224:227], v[60:63]
  v_mfma_f32_16x16x32_bf16 v[80:83], v[136:139], v[224:227], v[80:83]
  v_mfma_f32_16x16x32_bf16 v[84:87], v[140:143], v[224:227], v[84:87]
  v_mfma_f32_16x16x32_bf16 v[104:107], v[144:147], v[224:227], v[104:107]
  v_mfma_f32_16x16x32_bf16 v[108:111], v[148:151], v[224:227], v[108:111]
  s_waitcnt vmcnt(20)
  v_mfma_f32_16x16x32_bf16 v[32:35], v[128:131], v[228:231], v[32:35]
  s_add_u32 s38, s34, 49152
  buffer_load_dwordx4 v[224:227], v2, s[8:11], s38 offen sc1
  v_mfma_f32_16x16x32_bf16 v[36:39], v[132:135], v[228:231], v[36:39]
  v_mfma_f32_16x16x32_bf16 v[56:59], v[136:139], v[228:231], v[56:59]
  buffer_load_dwordx4 v[200:203], v7, s[8:11], s39 offen offset:0 sc1
  v_mfma_f32_16x16x32_bf16 v[60:63], v[140:143], v[228:231], v[60:63]
  v_mfma_f32_16x16x32_bf16 v[80:83], v[144:147], v[228:231], v[80:83]
  v_mfma_f32_16x16x32_bf16 v[84:87], v[148:151], v[228:231], v[84:87]
  v_mfma_f32_16x16x32_bf16 v[104:107], v[152:155], v[228:231], v[104:107]
  v_mfma_f32_16x16x32_bf16 v[108:111], v[156:159], v[228:231], v[108:111]
  s_waitcnt vmcnt(21)
  v_mfma_f32_16x16x32_bf16 v[30:33], v[112:115], v[232:235], v[30:33]
  s_add_u32 s38, s34, 55296
  buffer_load_dwordx4 v[228:231], v2, s[8:11], s38 offen sc1
  v_mfma_f32_16x16x32_bf16 v[34:37], v[116:119], v[232:235], v[34:37]
  v_mfma_f32_16x16x32_bf16 v[54:57], v[120:123], v[232:235], v[54:57]
  buffer_load_dwordx4 v[204:207], v7, s[8:11], s39 offen offset:1024 sc1
  v_mfma_f32_16x16x32_bf16 v[58:61], v[124:127], v[232:235], v[58:61]
  v_mfma_f32_16x16x32_bf16 v[78:81], v[128:131], v[232:235], v[78:81]
  v_mfma_f32_16x16x32_bf16 v[82:85], v[132:135], v[232:235], v[82:85]
  v_mfma_f32_16x16x32_bf16 v[102:105], v[136:139], v[232:235], v[102:105]
  v_mfma_f32_16x16x32_bf16 v[106:109], v[140:143], v[232:235], v[106:109]
  s_waitcnt vmcnt(21)
  v_mfma_f32_16x16x32_bf16 v[30:33], v[120:123], v[236:239], v[30:33]
  s_add_u32 s38, s34, 45056
  buffer_load_dwordx4 v[232:235], v2, s[8:11], s38 offen sc1
  v_mfma_f32_16x16x32_bf16 v[34:37], v[124:127], v[236:239], v[34:37]
  v_mfma_f32_16x16x32_bf16 v[54:57], v[128:131], v[236:239], v[54:57]
  v_mfma_f32_16x16x32_bf16 v[58:61], v[132:135], v[236:239], v[58:61]
  v_mfma_f32_16x16x32_bf16 v[78:81], v[136:139], v[236:239], v[78:81]
  v_mfma_f32_16x16x32_bf16 v[82:85], v[140:143], v[236:239], v[82:85]
  v_mfma_f32_16x16x32_bf16 v[102:105], v[144:147], v[236:239], v[102:105]
  v_mfma_f32_16x16x32_bf16 v[106:109], v[148:151], v[236:239], v[106:109]
  s_waitcnt vmcnt(20)
  v_mfma_f32_16x16x32_bf16 v[30:33], v[128:131], v[240:243], v[30:33]
  s_add_u32 s38, s34, 51200
  buffer_load_dwordx4 v[236:239], v2, s[8:11], s38 offen sc1
  v_mfma_f32_16x16x32_bf16 v[34:37], v[132:135], v[240:243], v[34:37]
  v_mfma_f32_16x16x32_bf16 v[54:57], v[136:139], v[240:243], v[54:57]
  v_mfma_f32_16x16x32_bf16 v[58:61], v[140:143], v[240:243], v[58:61]
  v_mfma_f32_16x16x32_bf16 v[78:81], v[144:147], v[240:243], v[78:81]
  v_mfma_f32_16x16x32_bf16 v[82:85], v[148:151], v[240:243], v[82:85]
  v_mfma_f32_16x16x32_bf16 v[102:105], v[152:155], v[240:243], v[102:105]
  v_mfma_f32_16x16x32_bf16 v[106:109], v[156:159], v[240:243], v[106:109]
  s_waitcnt vmcnt(19)
  v_mfma_f32_16x16x32_bf16 v[28:31], v[112:115], v[244:247], v[28:31]
  s_add_u32 s38, s34, 57344
  buffer_load_dwordx4 v[240:243], v2, s[8:11], s38 offen sc1
  v_mfma_f32_16x16x32_bf16 v[32:35], v[116:119], v[244:247], v[32:35]
  v_mfma_f32_16x16x32_bf16 v[52:55], v[120:123], v[244:247], v[52:55]
  v_mfma_f32_16x16x32_bf16 v[56:59], v[124:127], v[244:247], v[56:59]
  v_mfma_f32_16x16x32_bf16 v[76:79], v[128:131], v[244:247], v[76:79]
  v_mfma_f32_16x16x32_bf16 v[80:83], v[132:135], v[244:247], v[80:83]
  v_mfma_f32_16x16x32_bf16 v[100:103], v[136:139], v[244:247], v[100:103]
  v_mfma_f32_16x16x32_bf16 v[104:107], v[140:143], v[244:247], v[104:107]
  s_waitcnt vmcnt(18)
  v_mfma_f32_16x16x32_bf16 v[28:31], v[120:123], v[248:251], v[28:31]
  s_add_u32 s38, s34, 41984
  buffer_load_dwordx4 v[244:247], v2, s[8:11], s38 offen sc1
  v_mfma_f32_16x16x32_bf16 v[32:35], v[124:127], v[248:251], v[32:35]
  v_mfma_f32_16x16x32_bf16 v[52:55], v[128:131], v[248:251], v[52:55]
  v_mfma_f32_16x16x32_bf16 v[56:59], v[132:135], v[248:251], v[56:59]
  v_mfma_f32_16x16x32_bf16 v[76:79], v[136:139], v[248:251], v[76:79]
  v_mfma_f32_16x16x32_bf16 v[80:83], v[140:143], v[248:251], v[80:83]
  v_mfma_f32_16x16x32_bf16 v[100:103], v[144:147], v[248:251], v[100:103]
  v_mfma_f32_16x16x32_bf16 v[104:107], v[148:151], v[248:251], v[104:107]
  s_waitcnt vmcnt(17)
  v_mfma_f32_16x16x32_bf16 v[28:31], v[128:131], v[252:255], v[28:31]
  s_add_u32 s38, s34, 48128
  buffer_load_dwordx4 v[248:251], v2, s[8:11], s38 offen sc1
  v_mfma_f32_16x16x32_bf16 v[32:35], v[132:135], v[252:255], v[32:35]
  v_mfma_f32_16x16x32_bf16 v[52:55], v[136:139], v[252:255], v[52:55]
  v_mfma_f32_16x16x32_bf16 v[56:59], v[140:143], v[252:255], v[56:59]
  v_mfma_f32_16x16x32_bf16 v[76:79], v[144:147], v[252:255], v[76:79]
  v_mfma_f32_16x16x32_bf16 v[80:83], v[148:151], v[252:255], v[80:83]
  v_mfma_f32_16x16x32_bf16 v[100:103], v[152:155], v[252:255], v[100:103]
  v_mfma_f32_16x16x32_bf16 v[104:107], v[156:159], v[252:255], v[104:107]
  s_waitcnt vmcnt(16)
  v_mfma_f32_16x16x32_bf16 v[20:23], v[160:163], v[208:211], v[20:23]
  s_add_u32 s38, s34, 54272
  buffer_load_dwordx4 v[252:255], v2, s[8:11], s38 offen sc1
  v_mfma_f32_16x16x32_bf16 v[24:27], v[164:167], v[208:211], v[24:27]
  v_mfma_f32_16x16x32_bf16 v[44:47], v[168:171], v[208:211], v[44:47]
  v_mfma_f32_16x16x32_bf16 v[48:51], v[172:175], v[208:211], v[48:51]
  v_mfma_f32_16x16x32_bf16 v[68:71], v[176:179], v[208:211], v[68:71]
  v_mfma_f32_16x16x32_bf16 v[72:75], v[180:183], v[208:211], v[72:75]
  s_waitcnt vmcnt(16)
  v_mfma_f32_16x16x32_bf16 v[92:95], v[184:187], v[208:211], v[92:95]
  s_waitcnt vmcnt(14)
  v_mfma_f32_16x16x32_bf16 v[96:99], v[188:191], v[208:211], v[96:99]
  v_mfma_f32_16x16x32_bf16 v[20:23], v[168:171], v[212:215], v[20:23]
  s_add_u32 s38, s34, 44032
  buffer_load_dwordx4 v[208:211], v2, s[8:11], s38 offen sc1
  v_mfma_f32_16x16x32_bf16 v[24:27], v[172:175], v[212:215], v[24:27]
  v_mfma_f32_16x16x32_bf16 v[44:47], v[176:179], v[212:215], v[44:47]
  s_add_u32 s39, s32, 393216
  buffer_load_dwordx4 v[112:115], v6, s[8:11], s39 offen offset:0 sc1
  v_mfma_f32_16x16x32_bf16 v[48:51], v[180:183], v[212:215], v[48:51]
  v_mfma_f32_16x16x32_bf16 v[68:71], v[184:187], v[212:215], v[68:71]
  v_mfma_f32_16x16x32_bf16 v[72:75], v[188:191], v[212:215], v[72:75]
  s_waitcnt vmcnt(14)
  v_mfma_f32_16x16x32_bf16 v[92:95], v[192:195], v[212:215], v[92:95]
  s_waitcnt vmcnt(12)
  v_mfma_f32_16x16x32_bf16 v[96:99], v[196:199], v[212:215], v[96:99]
  v_mfma_f32_16x16x32_bf16 v[20:23], v[176:179], v[216:219], v[20:23]
  s_add_u32 s38, s34, 50176
  buffer_load_dwordx4 v[212:215], v2, s[8:11], s38 offen sc1
  v_mfma_f32_16x16x32_bf16 v[24:27], v[180:183], v[216:219], v[24:27]
  v_mfma_f32_16x16x32_bf16 v[44:47], v[184:187], v[216:219], v[44:47]
  buffer_load_dwordx4 v[116:119], v6, s[8:11], s39 offen offset:1024 sc1
  v_mfma_f32_16x16x32_bf16 v[48:51], v[188:191], v[216:219], v[48:51]
  v_mfma_f32_16x16x32_bf16 v[68:71], v[192:195], v[216:219], v[68:71]
  v_mfma_f32_16x16x32_bf16 v[72:75], v[196:199], v[216:219], v[72:75]
  s_waitcnt vmcnt(12)
  v_mfma_f32_16x16x32_bf16 v[92:95], v[200:203], v[216:219], v[92:95]
  s_waitcnt vmcnt(10)
  v_mfma_f32_16x16x32_bf16 v[96:99], v[204:207], v[216:219], v[96:99]
  v_mfma_f32_16x16x32_bf16 v[18:21], v[160:163], v[220:223], v[18:21]
  s_add_u32 s38, s34, 56320
  buffer_load_dwordx4 v[216:219], v2, s[8:11], s38 offen sc1
  v_mfma_f32_16x16x32_bf16 v[22:25], v[164:167], v[220:223], v[22:25]
  v_mfma_f32_16x16x32_bf16 v[42:45], v[168:171], v[220:223], v[42:45]
  buffer_load_dwordx4 v[120:123], v2, s[8:11], s39 offen offset:2048 sc1
  v_mfma_f32_16x16x32_bf16 v[46:49], v[172:175], v[220:223], v[46:49]
  v_mfma_f32_16x16x32_bf16 v[66:69], v[176:179], v[220:223], v[66:69]
  v_mfma_f32_16x16x32_bf16 v[70:73], v[180:183], v[220:223], v[70:73]
  v_mfma_f32_16x16x32_bf16 v[90:93], v[184:187], v[220:223], v[90:93]
  v_mfma_f32_16x16x32_bf16 v[94:97], v[188:191], v[220:223], v[94:97]
  v_mfma_f32_16x16x32_bf16 v[18:21], v[168:171], v[224:227], v[18:21]
  s_add_u32 s38, s34, 46080
  buffer_load_dwordx4 v[220:223], v2, s[8:11], s38 offen sc1
  v_mfma_f32_16x16x32_bf16 v[22:25], v[172:175], v[224:227], v[22:25]
  v_mfma_f32_16x16x32_bf16 v[42:45], v[176:179], v[224:227], v[42:45]
  buffer_load_dwordx4 v[124:127], v2, s[8:11], s39 offen offset:3072 sc1
  v_mfma_f32_16x16x32_bf16 v[46:49], v[180:183], v[224:227], v[46:49]
  v_mfma_f32_16x16x32_bf16 v[66:69], v[184:187], v[224:227], v[66:69]
  v_mfma_f32_16x16x32_bf16 v[70:73], v[188:191], v[224:227], v[70:73]
  v_mfma_f32_16x16x32_bf16 v[90:93], v[192:195], v[224:227], v[90:93]
  v_mfma_f32_16x16x32_bf16 v[94:97], v[196:199], v[224:227], v[94:97]
  v_mfma_f32_16x16x32_bf16 v[18:21], v[176:179], v[228:231], v[18:21]
  s_add_u32 s38, s34, 52224
  buffer_load_dwordx4 v[224:227], v2, s[8:11], s38 offen sc1
  v_mfma_f32_16x16x32_bf16 v[22:25], v[180:183], v[228:231], v[22:25]
  v_mfma_f32_16x16x32_bf16 v[42:45], v[184:187], v[228:231], v[42:45]
  buffer_load_dwordx4 v[128:131], v3, s[8:11], s39 offen offset:0 sc1
  v_mfma_f32_16x16x32_bf16 v[46:49], v[188:191], v[228:231], v[46:49]
  v_mfma_f32_16x16x32_bf16 v[66:69], v[192:195], v[228:231], v[66:69]
  v_mfma_f32_16x16x32_bf16 v[70:73], v[196:199], v[228:231], v[70:73]
  v_mfma_f32_16x16x32_bf16 v[90:93], v[200:203], v[228:231], v[90:93]
  v_mfma_f32_16x16x32_bf16 v[94:97], v[204:207], v[228:231], v[94:97]
  s_waitcnt vmcnt(15)
  v_mfma_f32_16x16x32_bf16 v[16:19], v[160:163], v[232:235], v[16:19]
  s_add_u32 s38, s34, 58368
  buffer_load_dwordx4 v[228:231], v2, s[8:11], s38 offen sc1
  v_mfma_f32_16x16x32_bf16 v[20:23], v[164:167], v[232:235], v[20:23]
  v_mfma_f32_16x16x32_bf16 v[40:43], v[168:171], v[232:235], v[40:43]
  buffer_load_dwordx4 v[132:135], v3, s[8:11], s39 offen offset:1024 sc1
  v_mfma_f32_16x16x32_bf16 v[44:47], v[172:175], v[232:235], v[44:47]
  v_mfma_f32_16x16x32_bf16 v[64:67], v[176:179], v[232:235], v[64:67]
  v_mfma_f32_16x16x32_bf16 v[68:71], v[180:183], v[232:235], v[68:71]
  v_mfma_f32_16x16x32_bf16 v[88:91], v[184:187], v[232:235], v[88:91]
  v_mfma_f32_16x16x32_bf16 v[92:95], v[188:191], v[232:235], v[92:95]
  s_waitcnt vmcnt(16)
  v_mfma_f32_16x16x32_bf16 v[16:19], v[168:171], v[236:239], v[16:19]
  s_add_u32 s38, s34, 61440
  buffer_load_dwordx4 v[232:235], v2, s[8:11], s38 offen sc1
  v_mfma_f32_16x16x32_bf16 v[20:23], v[172:175], v[236:239], v[20:23]
  v_mfma_f32_16x16x32_bf16 v[40:43], v[176:179], v[236:239], v[40:43]
  buffer_load_dwordx4 v[136:139], v3, s[8:11], s39 offen offset:2048 sc1
  v_mfma_f32_16x16x32_bf16 v[44:47], v[180:183], v[236:239], v[44:47]
  v_mfma_f32_16x16x32_bf16 v[64:67], v[184:187], v[236:239], v[64:67]
  v_mfma_f32_16x16x32_bf16 v[68:71], v[188:191], v[236:239], v[68:71]
  v_mfma_f32_16x16x32_bf16 v[88:91], v[192:195], v[236:239], v[88:91]
  v_mfma_f32_16x16x32_bf16 v[92:95], v[196:199], v[236:239], v[92:95]
  s_waitcnt vmcnt(17)
  v_mfma_f32_16x16x32_bf16 v[16:19], v[176:179], v[240:243], v[16:19]
  s_add_u32 s38, s34, 67584
  buffer_load_dwordx4 v[236:239], v2, s[8:11], s38 offen sc1
  v_mfma_f32_16x16x32_bf16 v[20:23], v[180:183], v[240:243], v[20:23]
  v_mfma_f32_16x16x32_bf16 v[40:43], v[184:187], v[240:243], v[40:43]
  buffer_load_dwordx4 v[140:143], v3, s[8:11], s39 offen offset:3072 sc1
  v_mfma_f32_16x16x32_bf16 v[44:47], v[188:191], v[240:243], v[44:47]
  v_mfma_f32_16x16x32_bf16 v[64:67], v[192:195], v[240:243], v[64:67]
  v_mfma_f32_16x16x32_bf16 v[68:71], v[196:199], v[240:243], v[68:71]
  v_mfma_f32_16x16x32_bf16 v[88:91], v[200:203], v[240:243], v[88:91]
  v_mfma_f32_16x16x32_bf16 v[92:95], v[204:207], v[240:243], v[92:95]
  s_waitcnt vmcnt(18)
  v_mfma_f32_16x16x32_bf16 v[32:35], v[160:163], v[244:247], v[32:35]
  s_add_u32 s38, s34, 73728
  buffer_load_dwordx4 v[240:243], v2, s[8:11], s38 offen sc1
  v_mfma_f32_16x16x32_bf16 v[36:39], v[164:167], v[244:247], v[36:39]
  v_mfma_f32_16x16x32_bf16 v[56:59], v[168:171], v[244:247], v[56:59]
  buffer_load_dwordx4 v[144:147], v4, s[8:11], s39 offen offset:0 sc1
  v_mfma_f32_16x16x32_bf16 v[60:63], v[172:175], v[244:247], v[60:63]
  v_mfma_f32_16x16x32_bf16 v[80:83], v[176:179], v[244:247], v[80:83]
  v_mfma_f32_16x16x32_bf16 v[84:87], v[180:183], v[244:247], v[84:87]
  v_mfma_f32_16x16x32_bf16 v[104:107], v[184:187], v[244:247], v[104:107]
  v_mfma_f32_16x16x32_bf16 v[108:111], v[188:191], v[244:247], v[108:111]
  s_waitcnt vmcnt(19)
  v_mfma_f32_16x16x32_bf16 v[32:35], v[168:171], v[248:251], v[32:35]
  s_add_u32 s38, s34, 63488
  buffer_load_dwordx4 v[244:247], v2, s[8:11], s38 offen sc1
  v_mfma_f32_16x16x32_bf16 v[36:39], v[172:175], v[248:251], v[36:39]
  v_mfma_f32_16x16x32_bf16 v[56:59], v[176:179], v[248:251], v[56:59]
  buffer_load_dwordx4 v[148:151], v4, s[8:11], s39 offen offset:1024 sc1
  v_mfma_f32_16x16x32_bf16 v[60:63], v[180:183], v[248:251], v[60:63]
  v_mfma_f32_16x16x32_bf16 v[80:83], v[184:187], v[248:251], v[80:83]
  v_mfma_f32_16x16x32_bf16 v[84:87], v[188:191], v[248:251], v[84:87]
  v_mfma_f32_16x16x32_bf16 v[104:107], v[192:195], v[248:251], v[104:107]
  v_mfma_f32_16x16x32_bf16 v[108:111], v[196:199], v[248:251], v[108:111]
  s_waitcnt vmcnt(20)
  v_mfma_f32_16x16x32_bf16 v[32:35], v[176:179], v[252:255], v[32:35]
  s_add_u32 s38, s34, 69632
  buffer_load_dwordx4 v[248:251], v2, s[8:11], s38 offen sc1
  v_mfma_f32_16x16x32_bf16 v[36:39], v[180:183], v[252:255], v[36:39]
  v_mfma_f32_16x16x32_bf16 v[56:59], v[184:187], v[252:255], v[56:59]
  buffer_load_dwordx4 v[152:155], v7, s[8:11], s39 offen offset:0 sc1
  v_mfma_f32_16x16x32_bf16 v[60:63], v[188:191], v[252:255], v[60:63]
  v_mfma_f32_16x16x32_bf16 v[80:83], v[192:195], v[252:255], v[80:83]
  v_mfma_f32_16x16x32_bf16 v[84:87], v[196:199], v[252:255], v[84:87]
  v_mfma_f32_16x16x32_bf16 v[104:107], v[200:203], v[252:255], v[104:107]
  v_mfma_f32_16x16x32_bf16 v[108:111], v[204:207], v[252:255], v[108:111]
  s_waitcnt vmcnt(21)
  v_mfma_f32_16x16x32_bf16 v[30:33], v[160:163], v[208:211], v[30:33]
  s_add_u32 s38, s34, 75776
  buffer_load_dwordx4 v[252:255], v2, s[8:11], s38 offen sc1
  v_mfma_f32_16x16x32_bf16 v[34:37], v[164:167], v[208:211], v[34:37]
  v_mfma_f32_16x16x32_bf16 v[54:57], v[168:171], v[208:211], v[54:57]
  buffer_load_dwordx4 v[156:159], v7, s[8:11], s39 offen offset:1024 sc1
  v_mfma_f32_16x16x32_bf16 v[58:61], v[172:175], v[208:211], v[58:61]
  v_mfma_f32_16x16x32_bf16 v[78:81], v[176:179], v[208:211], v[78:81]
  v_mfma_f32_16x16x32_bf16 v[82:85], v[180:183], v[208:211], v[82:85]
  v_mfma_f32_16x16x32_bf16 v[102:105], v[184:187], v[208:211], v[102:105]
  v_mfma_f32_16x16x32_bf16 v[106:109], v[188:191], v[208:211], v[106:109]
  s_waitcnt vmcnt(21)
  v_mfma_f32_16x16x32_bf16 v[30:33], v[168:171], v[212:215], v[30:33]
  s_add_u32 s38, s34, 65536
  buffer_load_dwordx4 v[208:211], v2, s[8:11], s38 offen sc1
  v_mfma_f32_16x16x32_bf16 v[34:37], v[172:175], v[212:215], v[34:37]
  v_mfma_f32_16x16x32_bf16 v[54:57], v[176:179], v[212:215], v[54:57]
  v_mfma_f32_16x16x32_bf16 v[58:61], v[180:183], v[212:215], v[58:61]
  v_mfma_f32_16x16x32_bf16 v[78:81], v[184:187], v[212:215], v[78:81]
  v_mfma_f32_16x16x32_bf16 v[82:85], v[188:191], v[212:215], v[82:85]
  v_mfma_f32_16x16x32_bf16 v[102:105], v[192:195], v[212:215], v[102:105]
  v_mfma_f32_16x16x32_bf16 v[106:109], v[196:199], v[212:215], v[106:109]
  s_waitcnt vmcnt(20)
  v_mfma_f32_16x16x32_bf16 v[30:33], v[176:179], v[216:219], v[30:33]
  s_add_u32 s38, s34, 71680
  buffer_load_dwordx4 v[212:215], v2, s[8:11], s38 offen sc1
  v_mfma_f32_16x16x32_bf16 v[34:37], v[180:183], v[216:219], v[34:37]
  v_mfma_f32_16x16x32_bf16 v[54:57], v[184:187], v[216:219], v[54:57]
  v_mfma_f32_16x16x32_bf16 v[58:61], v[188:191], v[216:219], v[58:61]
  v_mfma_f32_16x16x32_bf16 v[78:81], v[192:195], v[216:219], v[78:81]
  v_mfma_f32_16x16x32_bf16 v[82:85], v[196:199], v[216:219], v[82:85]
  v_mfma_f32_16x16x32_bf16 v[102:105], v[200:203], v[216:219], v[102:105]
  v_mfma_f32_16x16x32_bf16 v[106:109], v[204:207], v[216:219], v[106:109]
  s_waitcnt vmcnt(19)
  v_mfma_f32_16x16x32_bf16 v[28:31], v[160:163], v[220:223], v[28:31]
  s_add_u32 s38, s34, 77824
  buffer_load_dwordx4 v[216:219], v2, s[8:11], s38 offen sc1
  v_mfma_f32_16x16x32_bf16 v[32:35], v[164:167], v[220:223], v[32:35]
  v_mfma_f32_16x16x32_bf16 v[52:55], v[168:171], v[220:223], v[52:55]
  v_mfma_f32_16x16x32_bf16 v[56:59], v[172:175], v[220:223], v[56:59]
  v_mfma_f32_16x16x32_bf16 v[76:79], v[176:179], v[220:223], v[76:79]
  v_mfma_f32_16x16x32_bf16 v[80:83], v[180:183], v[220:223], v[80:83]
  v_mfma_f32_16x16x32_bf16 v[100:103], v[184:187], v[220:223], v[100:103]
  v_mfma_f32_16x16x32_bf16 v[104:107], v[188:191], v[220:223], v[104:107]
  s_waitcnt vmcnt(18)
  v_mfma_f32_16x16x32_bf16 v[28:31], v[168:171], v[224:227], v[28:31]
  s_add_u32 s38, s34, 62464
  buffer_load_dwordx4 v[220:223], v2, s[8:11], s38 offen sc1
  v_mfma_f32_16x16x32_bf16 v[32:35], v[172:175], v[224:227], v[32:35]
  v_mfma_f32_16x16x32_bf16 v[52:55], v[176:179], v[224:227], v[52:55]
  v_mfma_f32_16x16x32_bf16 v[56:59], v[180:183], v[224:227], v[56:59]
  v_mfma_f32_16x16x32_bf16 v[76:79], v[184:187], v[224:227], v[76:79]
  v_mfma_f32_16x16x32_bf16 v[80:83], v[188:191], v[224:227], v[80:83]
  v_mfma_f32_16x16x32_bf16 v[100:103], v[192:195], v[224:227], v[100:103]
  v_mfma_f32_16x16x32_bf16 v[104:107], v[196:199], v[224:227], v[104:107]
  s_waitcnt vmcnt(17)
  v_mfma_f32_16x16x32_bf16 v[28:31], v[176:179], v[228:231], v[28:31]
  s_add_u32 s38, s34, 68608
  buffer_load_dwordx4 v[224:227], v2, s[8:11], s38 offen sc1
  v_mfma_f32_16x16x32_bf16 v[32:35], v[180:183], v[228:231], v[32:35]
  v_mfma_f32_16x16x32_bf16 v[52:55], v[184:187], v[228:231], v[52:55]
  v_mfma_f32_16x16x32_bf16 v[56:59], v[188:191], v[228:231], v[56:59]
  v_mfma_f32_16x16x32_bf16 v[76:79], v[192:195], v[228:231], v[76:79]
  v_mfma_f32_16x16x32_bf16 v[80:83], v[196:199], v[228:231], v[80:83]
  v_mfma_f32_16x16x32_bf16 v[100:103], v[200:203], v[228:231], v[100:103]
  v_mfma_f32_16x16x32_bf16 v[104:107], v[204:207], v[228:231], v[104:107]
  s_waitcnt vmcnt(16)
  v_mfma_f32_16x16x32_bf16 v[20:23], v[112:115], v[232:235], v[20:23]
  s_add_u32 s38, s34, 74752
  buffer_load_dwordx4 v[228:231], v2, s[8:11], s38 offen sc1
  v_mfma_f32_16x16x32_bf16 v[24:27], v[116:119], v[232:235], v[24:27]
  v_mfma_f32_16x16x32_bf16 v[44:47], v[120:123], v[232:235], v[44:47]
  v_mfma_f32_16x16x32_bf16 v[48:51], v[124:127], v[232:235], v[48:51]
  v_mfma_f32_16x16x32_bf16 v[68:71], v[128:131], v[232:235], v[68:71]
  v_mfma_f32_16x16x32_bf16 v[72:75], v[132:135], v[232:235], v[72:75]
  s_waitcnt vmcnt(16)
  v_mfma_f32_16x16x32_bf16 v[92:95], v[136:139], v[232:235], v[92:95]
  s_waitcnt vmcnt(14)
  v_mfma_f32_16x16x32_bf16 v[96:99], v[140:143], v[232:235], v[96:99]
  v_mfma_f32_16x16x32_bf16 v[20:23], v[120:123], v[236:239], v[20:23]
  s_add_u32 s38, s34, 64512
  buffer_load_dwordx4 v[232:235], v2, s[8:11], s38 offen sc1
  v_mfma_f32_16x16x32_bf16 v[24:27], v[124:127], v[236:239], v[24:27]
  v_mfma_f32_16x16x32_bf16 v[44:47], v[128:131], v[236:239], v[44:47]
  v_mfma_f32_16x16x32_bf16 v[48:51], v[132:135], v[236:239], v[48:51]
  v_mfma_f32_16x16x32_bf16 v[68:71], v[136:139], v[236:239], v[68:71]
  v_mfma_f32_16x16x32_bf16 v[72:75], v[140:143], v[236:239], v[72:75]
  s_waitcnt vmcnt(13)
  v_mfma_f32_16x16x32_bf16 v[92:95], v[144:147], v[236:239], v[92:95]
  s_waitcnt vmcnt(11)
  v_mfma_f32_16x16x32_bf16 v[96:99], v[148:151], v[236:239], v[96:99]
  v_mfma_f32_16x16x32_bf16 v[20:23], v[128:131], v[240:243], v[20:23]
  s_add_u32 s38, s34, 70656
  buffer_load_dwordx4 v[236:239], v2, s[8:11], s38 offen sc1
  v_mfma_f32_16x16x32_bf16 v[24:27], v[132:135], v[240:243], v[24:27]
  v_mfma_f32_16x16x32_bf16 v[44:47], v[136:139], v[240:243], v[44:47]
  v_mfma_f32_16x16x32_bf16 v[48:51], v[140:143], v[240:243], v[48:51]
  v_mfma_f32_16x16x32_bf16 v[68:71], v[144:147], v[240:243], v[68:71]
  v_mfma_f32_16x16x32_bf16 v[72:75], v[148:151], v[240:243], v[72:75]
  s_waitcnt vmcnt(10)
  v_mfma_f32_16x16x32_bf16 v[92:95], v[152:155], v[240:243], v[92:95]
  s_waitcnt vmcnt(8)
  v_mfma_f32_16x16x32_bf16 v[96:99], v[156:159], v[240:243], v[96:99]
  v_mfma_f32_16x16x32_bf16 v[18:21], v[112:115], v[244:247], v[18:21]
  s_add_u32 s38, s34, 76800
  buffer_load_dwordx4 v[240:243], v2, s[8:11], s38 offen sc1
  v_mfma_f32_16x16x32_bf16 v[22:25], v[116:119], v[244:247], v[22:25]
  v_mfma_f32_16x16x32_bf16 v[42:45], v[120:123], v[244:247], v[42:45]
  v_mfma_f32_16x16x32_bf16 v[46:49], v[124:127], v[244:247], v[46:49]
  v_mfma_f32_16x16x32_bf16 v[66:69], v[128:131], v[244:247], v[66:69]
  v_mfma_f32_16x16x32_bf16 v[70:73], v[132:135], v[244:247], v[70:73]
  v_mfma_f32_16x16x32_bf16 v[90:93], v[136:139], v[244:247], v[90:93]
  v_mfma_f32_16x16x32_bf16 v[94:97], v[140:143], v[244:247], v[94:97]
  v_mfma_f32_16x16x32_bf16 v[18:21], v[120:123], v[248:251], v[18:21]
  s_add_u32 s38, s34, 66560
  buffer_load_dwordx4 v[244:247], v2, s[8:11], s38 offen sc1
  v_mfma_f32_16x16x32_bf16 v[22:25], v[124:127], v[248:251], v[22:25]
  v_mfma_f32_16x16x32_bf16 v[42:45], v[128:131], v[248:251], v[42:45]
  v_mfma_f32_16x16x32_bf16 v[46:49], v[132:135], v[248:251], v[46:49]
  v_mfma_f32_16x16x32_bf16 v[66:69], v[136:139], v[248:251], v[66:69]
  v_mfma_f32_16x16x32_bf16 v[70:73], v[140:143], v[248:251], v[70:73]
  v_mfma_f32_16x16x32_bf16 v[90:93], v[144:147], v[248:251], v[90:93]
  v_mfma_f32_16x16x32_bf16 v[94:97], v[148:151], v[248:251], v[94:97]
  v_mfma_f32_16x16x32_bf16 v[18:21], v[128:131], v[252:255], v[18:21]
  s_add_u32 s38, s34, 72704
  buffer_load_dwordx4 v[248:251], v2, s[8:11], s38 offen sc1
  v_mfma_f32_16x16x32_bf16 v[22:25], v[132:135], v[252:255], v[22:25]
  v_mfma_f32_16x16x32_bf16 v[42:45], v[136:139], v[252:255], v[42:45]
  v_mfma_f32_16x16x32_bf16 v[46:49], v[140:143], v[252:255], v[46:49]
  v_mfma_f32_16x16x32_bf16 v[66:69], v[144:147], v[252:255], v[66:69]
  v_mfma_f32_16x16x32_bf16 v[70:73], v[148:151], v[252:255], v[70:73]
  v_mfma_f32_16x16x32_bf16 v[90:93], v[152:155], v[252:255], v[90:93]
  v_mfma_f32_16x16x32_bf16 v[94:97], v[156:159], v[252:255], v[94:97]
  s_waitcnt vmcnt(10)
  v_mfma_f32_16x16x32_bf16 v[16:19], v[112:115], v[208:211], v[16:19]
  s_add_u32 s38, s34, 78848
  buffer_load_dwordx4 v[252:255], v2, s[8:11], s38 offen sc1
  buffer_load_dwordx2 v[8:9], v1, s[12:15], s36 offen offset:0
  buffer_load_dwordx2 v[10:11], v1, s[12:15], s36 offen offset:1024
  buffer_load_dwordx2 v[12:13], v1, s[12:15], s36 offen offset:2048
  buffer_load_dwordx2 v[14:15], v1, s[12:15], s36 offen offset:3072
  v_mfma_f32_16x16x32_bf16 v[20:23], v[116:119], v[208:211], v[20:23]
  v_mfma_f32_16x16x32_bf16 v[40:43], v[120:123], v[208:211], v[40:43]
  v_mfma_f32_16x16x32_bf16 v[44:47], v[124:127], v[208:211], v[44:47]
  v_mfma_f32_16x16x32_bf16 v[64:67], v[128:131], v[208:211], v[64:67]
  v_mfma_f32_16x16x32_bf16 v[68:71], v[132:135], v[208:211], v[68:71]
  v_mfma_f32_16x16x32_bf16 v[88:91], v[136:139], v[208:211], v[88:91]
  v_mfma_f32_16x16x32_bf16 v[92:95], v[140:143], v[208:211], v[92:95]
  s_waitcnt vmcnt(14)
  v_mfma_f32_16x16x32_bf16 v[16:19], v[120:123], v[212:215], v[16:19]
  v_mfma_f32_16x16x32_bf16 v[20:23], v[124:127], v[212:215], v[20:23]
  v_mfma_f32_16x16x32_bf16 v[40:43], v[128:131], v[212:215], v[40:43]
  v_mfma_f32_16x16x32_bf16 v[44:47], v[132:135], v[212:215], v[44:47]
  v_mfma_f32_16x16x32_bf16 v[64:67], v[136:139], v[212:215], v[64:67]
  v_mfma_f32_16x16x32_bf16 v[68:71], v[140:143], v[212:215], v[68:71]
  v_mfma_f32_16x16x32_bf16 v[88:91], v[144:147], v[212:215], v[88:91]
  v_mfma_f32_16x16x32_bf16 v[92:95], v[148:151], v[212:215], v[92:95]
  s_waitcnt vmcnt(13)
  v_mfma_f32_16x16x32_bf16 v[16:19], v[128:131], v[216:219], v[16:19]
  v_mfma_f32_16x16x32_bf16 v[20:23], v[132:135], v[216:219], v[20:23]
  v_mfma_f32_16x16x32_bf16 v[40:43], v[136:139], v[216:219], v[40:43]
  v_mfma_f32_16x16x32_bf16 v[44:47], v[140:143], v[216:219], v[44:47]
  v_mfma_f32_16x16x32_bf16 v[64:67], v[144:147], v[216:219], v[64:67]
  v_mfma_f32_16x16x32_bf16 v[68:71], v[148:151], v[216:219], v[68:71]
  v_mfma_f32_16x16x32_bf16 v[88:91], v[152:155], v[216:219], v[88:91]
  v_mfma_f32_16x16x32_bf16 v[92:95], v[156:159], v[216:219], v[92:95]
  s_waitcnt vmcnt(12)
  v_mfma_f32_16x16x32_bf16 v[32:35], v[112:115], v[220:223], v[32:35]
  v_mfma_f32_16x16x32_bf16 v[36:39], v[116:119], v[220:223], v[36:39]
  v_mfma_f32_16x16x32_bf16 v[56:59], v[120:123], v[220:223], v[56:59]
  v_mfma_f32_16x16x32_bf16 v[60:63], v[124:127], v[220:223], v[60:63]
  v_mfma_f32_16x16x32_bf16 v[80:83], v[128:131], v[220:223], v[80:83]
  v_mfma_f32_16x16x32_bf16 v[84:87], v[132:135], v[220:223], v[84:87]
  v_mfma_f32_16x16x32_bf16 v[104:107], v[136:139], v[220:223], v[104:107]
  v_mfma_f32_16x16x32_bf16 v[108:111], v[140:143], v[220:223], v[108:111]
  s_lshl_b32 s38, s3, 12
  s_mov_b32 m0, s38
  v_lshlrev_b32 v4, 2, v0
  v_add_u32 v5, 64, v4
  v_subrev_u32 v4, 64, v4
  v_and_b32 v4, 0xff, v4
  v_and_b32 v5, 0xff, v5
  s_mov_b32 s40, 0xffff0000
  s_mov_b32 s41, -1
  s_mov_b32 s42, -1
  s_mov_b32 s43, 0xffff

  s_waitcnt vmcnt(11)
  v_mfma_f32_16x16x32_bf16 v[32:35], v[120:123], v[224:227], v[32:35]
  ds_bpermute_b32 v27, v4, v27
  v_mfma_f32_16x16x32_bf16 v[36:39], v[124:127], v[224:227], v[36:39]
  ds_bpermute_b32 v16, v5, v16
  v_mfma_f32_16x16x32_bf16 v[56:59], v[128:131], v[224:227], v[56:59]
  v_add_f32 v19, v19, v26
  v_mfma_f32_16x16x32_bf16 v[60:63], v[132:135], v[224:227], v[60:63]
  v_add_f32 v24, v24, v17
  v_mfma_f32_16x16x32_bf16 v[80:83], v[136:139], v[224:227], v[80:83]
  ds_bpermute_b32 v51, v4, v51
  v_mfma_f32_16x16x32_bf16 v[84:87], v[140:143], v[224:227], v[84:87]
  ds_bpermute_b32 v40, v5, v40
  v_mfma_f32_16x16x32_bf16 v[104:107], v[144:147], v[224:227], v[104:107]
  v_add_f32 v43, v43, v50
  v_mfma_f32_16x16x32_bf16 v[108:111], v[148:151], v[224:227], v[108:111]
  v_add_f32 v48, v48, v41
  s_waitcnt vmcnt(10)
  v_mfma_f32_16x16x32_bf16 v[32:35], v[128:131], v[228:231], v[32:35]
  ds_bpermute_b32 v75, v4, v75
  v_mfma_f32_16x16x32_bf16 v[36:39], v[132:135], v[228:231], v[36:39]
  ds_bpermute_b32 v64, v5, v64
  v_mfma_f32_16x16x32_bf16 v[56:59], v[136:139], v[228:231], v[56:59]
  v_add_f32 v67, v67, v74
  v_mfma_f32_16x16x32_bf16 v[60:63], v[140:143], v[228:231], v[60:63]
  v_add_f32 v72, v72, v65
  v_mfma_f32_16x16x32_bf16 v[80:83], v[144:147], v[228:231], v[80:83]
  ds_bpermute_b32 v99, v4, v99
  v_mfma_f32_16x16x32_bf16 v[84:87], v[148:151], v[228:231], v[84:87]
  ds_bpermute_b32 v88, v5, v88
  v_mfma_f32_16x16x32_bf16 v[104:107], v[152:155], v[228:231], v[104:107]
  v_add_f32 v91, v91, v98
  v_mfma_f32_16x16x32_bf16 v[108:111], v[156:159], v[228:231], v[108:111]
  v_add_f32 v96, v96, v89
  s_waitcnt vmcnt(9)
  v_mfma_f32_16x16x32_bf16 v[30:33], v[112:115], v[232:235], v[30:33]
  ds_write_addtid_b32 v19 offset:512
  v_mfma_f32_16x16x32_bf16 v[34:37], v[116:119], v[232:235], v[34:37]
  ds_write_addtid_b32 v20 offset:1024
  v_mfma_f32_16x16x32_bf16 v[54:57], v[120:123], v[232:235], v[54:57]
  ds_write_addtid_b32 v21 offset:1536
  v_mfma_f32_16x16x32_bf16 v[58:61], v[124:127], v[232:235], v[58:61]
  ds_write_addtid_b32 v22 offset:2048
  v_mfma_f32_16x16x32_bf16 v[78:81], v[128:131], v[232:235], v[78:81]
  ds_write_addtid_b32 v23 offset:2560
  v_mfma_f32_16x16x32_bf16 v[82:85], v[132:135], v[232:235], v[82:85]
  ds_write_addtid_b32 v24 offset:3072
  v_mfma_f32_16x16x32_bf16 v[102:105], v[136:139], v[232:235], v[102:105]
  ds_write_addtid_b32 v43 offset:16896
  v_mfma_f32_16x16x32_bf16 v[106:109], v[140:143], v[232:235], v[106:109]
  ds_write_addtid_b32 v44 offset:17408
  s_waitcnt vmcnt(8)
  v_mfma_f32_16x16x32_bf16 v[30:33], v[120:123], v[236:239], v[30:33]
  ds_write_addtid_b32 v45 offset:17920
  v_mfma_f32_16x16x32_bf16 v[34:37], v[124:127], v[236:239], v[34:37]
  ds_write_addtid_b32 v46 offset:18432
  v_mfma_f32_16x16x32_bf16 v[54:57], v[128:131], v[236:239], v[54:57]
  ds_write_addtid_b32 v47 offset:18944
  v_mfma_f32_16x16x32_bf16 v[58:61], v[132:135], v[236:239], v[58:61]
  ds_write_addtid_b32 v48 offset:19456
  v_mfma_f32_16x16x32_bf16 v[78:81], v[136:139], v[236:239], v[78:81]
  ds_write_addtid_b32 v67 offset:33280
  v_mfma_f32_16x16x32_bf16 v[82:85], v[140:143], v[236:239], v[82:85]
  ds_write_addtid_b32 v68 offset:33792
  v_mfma_f32_16x16x32_bf16 v[102:105], v[144:147], v[236:239], v[102:105]
  ds_write_addtid_b32 v69 offset:34304
  v_mfma_f32_16x16x32_bf16 v[106:109], v[148:151], v[236:239], v[106:109]
  ds_write_addtid_b32 v70 offset:34816
  s_waitcnt vmcnt(7)
  v_mfma_f32_16x16x32_bf16 v[30:33], v[128:131], v[240:243], v[30:33]
  ds_write_addtid_b32 v71 offset:35328
  v_mfma_f32_16x16x32_bf16 v[34:37], v[132:135], v[240:243], v[34:37]
  ds_write_addtid_b32 v72 offset:35840
  v_mfma_f32_16x16x32_bf16 v[54:57], v[136:139], v[240:243], v[54:57]
  ds_write_addtid_b32 v91 offset:49664
  v_mfma_f32_16x16x32_bf16 v[58:61], v[140:143], v[240:243], v[58:61]
  ds_write_addtid_b32 v92 offset:50176
  v_mfma_f32_16x16x32_bf16 v[78:81], v[144:147], v[240:243], v[78:81]
  ds_write_addtid_b32 v93 offset:50688
  v_mfma_f32_16x16x32_bf16 v[82:85], v[148:151], v[240:243], v[82:85]
  ds_write_addtid_b32 v94 offset:51200
  v_mfma_f32_16x16x32_bf16 v[102:105], v[152:155], v[240:243], v[102:105]
  ds_write_addtid_b32 v95 offset:51712
  v_mfma_f32_16x16x32_bf16 v[106:109], v[156:159], v[240:243], v[106:109]
  ds_write_addtid_b32 v96 offset:52224
  s_waitcnt vmcnt(6)
  v_mfma_f32_16x16x32_bf16 v[28:31], v[112:115], v[244:247], v[28:31]
  s_waitcnt lgkmcnt(15)
  v_mfma_f32_16x16x32_bf16 v[32:35], v[116:119], v[244:247], v[32:35]
  v_cndmask_b32 v27, 0, v27, s[40:41]
  v_mfma_f32_16x16x32_bf16 v[52:55], v[120:123], v[244:247], v[52:55]
  v_cndmask_b32 v16, 0, v16, s[42:43]
  v_mfma_f32_16x16x32_bf16 v[56:59], v[124:127], v[244:247], v[56:59]
  v_add_f32 v18, v18, v27
  v_mfma_f32_16x16x32_bf16 v[76:79], v[128:131], v[244:247], v[76:79]
  v_add_f32 v25, v25, v16
  v_mfma_f32_16x16x32_bf16 v[80:83], v[132:135], v[244:247], v[80:83]
  ds_write_addtid_b32 v18 offset:0
  v_mfma_f32_16x16x32_bf16 v[100:103], v[136:139], v[244:247], v[100:103]
  ds_write_addtid_b32 v25 offset:3584
  v_mfma_f32_16x16x32_bf16 v[104:107], v[140:143], v[244:247], v[104:107]
  v_cndmask_b32 v51, 0, v51, s[40:41]
  s_waitcnt vmcnt(5)
  v_mfma_f32_16x16x32_bf16 v[28:31], v[120:123], v[248:251], v[28:31]
  v_cndmask_b32 v40, 0, v40, s[42:43]
  v_mfma_f32_16x16x32_bf16 v[32:35], v[124:127], v[248:251], v[32:35]
  v_add_f32 v42, v42, v51
  v_mfma_f32_16x16x32_bf16 v[52:55], v[128:131], v[248:251], v[52:55]
  v_add_f32 v49, v49, v40
  v_mfma_f32_16x16x32_bf16 v[56:59], v[132:135], v[248:251], v[56:59]
  ds_write_addtid_b32 v42 offset:16384
  v_mfma_f32_16x16x32_bf16 v[76:79], v[136:139], v[248:251], v[76:79]
  ds_write_addtid_b32 v49 offset:19968
  v_mfma_f32_16x16x32_bf16 v[80:83], v[140:143], v[248:251], v[80:83]
  v_cndmask_b32 v75, 0, v75, s[40:41]
  v_mfma_f32_16x16x32_bf16 v[100:103], v[144:147], v[248:251], v[100:103]
  v_cndmask_b32 v64, 0, v64, s[42:43]
  v_mfma_f32_16x16x32_bf16 v[104:107], v[148:151], v[248:251], v[104:107]
  v_add_f32 v66, v66, v75
  s_waitcnt vmcnt(4)
  v_mfma_f32_16x16x32_bf16 v[28:31], v[128:131], v[252:255], v[28:31]
  v_add_f32 v73, v73, v64
  v_mfma_f32_16x16x32_bf16 v[32:35], v[132:135], v[252:255], v[32:35]
  ds_write_addtid_b32 v66 offset:32768
  v_mfma_f32_16x16x32_bf16 v[52:55], v[136:139], v[252:255], v[52:55]
  ds_write_addtid_b32 v73 offset:36352
  v_mfma_f32_16x16x32_bf16 v[56:59], v[140:143], v[252:255], v[56:59]
  v_cndmask_b32 v99, 0, v99, s[40:41]
  v_mfma_f32_16x16x32_bf16 v[76:79], v[144:147], v[252:255], v[76:79]
  v_cndmask_b32 v88, 0, v88, s[42:43]
  v_mfma_f32_16x16x32_bf16 v[80:83], v[148:151], v[252:255], v[80:83]
  v_add_f32 v90, v90, v99
  v_mfma_f32_16x16x32_bf16 v[100:103], v[152:155], v[252:255], v[100:103]
  v_add_f32 v97, v97, v88
  v_mfma_f32_16x16x32_bf16 v[104:107], v[156:159], v[252:255], v[104:107]
  ds_write_addtid_b32 v90 offset:49152
  ds_write_addtid_b32 v97 offset:52736
  s_nop 7
  ds_bpermute_b32 v39, v4, v39
  ds_bpermute_b32 v28, v5, v28
  v_add_f32 v31, v31, v38
  v_add_f32 v36, v36, v29
  ds_bpermute_b32 v63, v4, v63
  ds_bpermute_b32 v52, v5, v52
  v_add_f32 v55, v55, v62
  v_add_f32 v60, v60, v53
  ds_bpermute_b32 v87, v4, v87
  ds_bpermute_b32 v76, v5, v76
  v_add_f32 v79, v79, v86
  v_add_f32 v84, v84, v77
  ds_bpermute_b32 v111, v4, v111
  ds_bpermute_b32 v100, v5, v100
  v_add_f32 v103, v103, v110
  v_add_f32 v108, v108, v101
  ds_write_addtid_b32 v31 offset:768
  ds_write_addtid_b32 v32 offset:1280
  ds_write_addtid_b32 v33 offset:1792
  ds_write_addtid_b32 v34 offset:2304
  ds_write_addtid_b32 v35 offset:2816
  ds_write_addtid_b32 v36 offset:3328
  ds_write_addtid_b32 v55 offset:17152
  ds_write_addtid_b32 v56 offset:17664
  ds_write_addtid_b32 v57 offset:18176
  ds_write_addtid_b32 v58 offset:18688
  ds_write_addtid_b32 v59 offset:19200
  ds_write_addtid_b32 v60 offset:19712
  ds_write_addtid_b32 v79 offset:33536
  ds_write_addtid_b32 v80 offset:34048
  ds_write_addtid_b32 v81 offset:34560
  ds_write_addtid_b32 v82 offset:35072
  ds_write_addtid_b32 v83 offset:35584
  ds_write_addtid_b32 v84 offset:36096
  ds_write_addtid_b32 v103 offset:49920
  ds_write_addtid_b32 v104 offset:50432
  ds_write_addtid_b32 v105 offset:50944
  ds_write_addtid_b32 v106 offset:51456
  ds_write_addtid_b32 v107 offset:51968
  ds_write_addtid_b32 v108 offset:52480
  s_waitcnt lgkmcnt(15)
  v_cndmask_b32 v39, 0, v39, s[40:41]
  v_cndmask_b32 v28, 0, v28, s[42:43]
  v_add_f32 v30, v30, v39
  v_add_f32 v37, v37, v28
  ds_write_addtid_b32 v30 offset:256
  ds_write_addtid_b32 v37 offset:3840
  v_cndmask_b32 v63, 0, v63, s[40:41]
  v_cndmask_b32 v52, 0, v52, s[42:43]
  v_add_f32 v54, v54, v63
  v_add_f32 v61, v61, v52
  ds_write_addtid_b32 v54 offset:16640
  ds_write_addtid_b32 v61 offset:20224
  v_cndmask_b32 v87, 0, v87, s[40:41]
  v_cndmask_b32 v76, 0, v76, s[42:43]
  v_add_f32 v78, v78, v87
  v_add_f32 v85, v85, v76
  ds_write_addtid_b32 v78 offset:33024
  ds_write_addtid_b32 v85 offset:36608
  v_cndmask_b32 v111, 0, v111, s[40:41]
  v_cndmask_b32 v100, 0, v100, s[42:43]
  v_add_f32 v102, v102, v111
  v_add_f32 v109, v109, v100
  ds_write_addtid_b32 v102 offset:49408
  ds_write_addtid_b32 v109 offset:52992
  s_lshl_b32 s38, s3, 14
  v_add_u32 v112, s38, v2
  s_waitcnt lgkmcnt(0)
  s_barrier
  ds_read_b128 v[116:119], v112 offset:0
  ds_read_b128 v[132:135], v112 offset:4096
  ds_read_b128 v[148:151], v112 offset:8192
  ds_read_b128 v[164:167], v112 offset:12288
  ds_read_b128 v[120:123], v112 offset:1024
  ds_read_b128 v[136:139], v112 offset:5120
  ds_read_b128 v[152:155], v112 offset:9216
  ds_read_b128 v[168:171], v112 offset:13312
  ds_read_b128 v[124:127], v112 offset:2048
  ds_read_b128 v[140:143], v112 offset:6144
  ds_read_b128 v[156:159], v112 offset:10240
  ds_read_b128 v[172:175], v112 offset:14336
  ds_read_b128 v[128:131], v112 offset:3072
  ds_read_b128 v[144:147], v112 offset:7168
  ds_read_b128 v[160:163], v112 offset:11264
  ds_read_b128 v[176:179], v112 offset:15360
  s_waitcnt vmcnt(0)
  v_lshlrev_b32 v184, 16, v8
  v_and_b32 v185, 0xffff0000, v8
  v_lshlrev_b32 v186, 16, v9
  v_and_b32 v187, 0xffff0000, v9
  v_lshlrev_b32 v188, 16, v10
  v_and_b32 v189, 0xffff0000, v10
  v_lshlrev_b32 v190, 16, v11
  v_and_b32 v191, 0xffff0000, v11
  v_lshlrev_b32 v192, 16, v12
  v_and_b32 v193, 0xffff0000, v12
  v_lshlrev_b32 v194, 16, v13
  v_and_b32 v195, 0xffff0000, v13
  v_lshlrev_b32 v196, 16, v14
  v_and_b32 v197, 0xffff0000, v14
  v_lshlrev_b32 v198, 16, v15
  v_and_b32 v199, 0xffff0000, v15
  s_waitcnt lgkmcnt(12)
  v_pk_add_f32 v[116:117], v[116:117], v[132:133]
  v_pk_add_f32 v[148:149], v[148:149], v[164:165]
  v_pk_add_f32 v[118:119], v[118:119], v[134:135]
  v_pk_add_f32 v[150:151], v[150:151], v[166:167]
  v_pk_add_f32 v[116:117], v[116:117], v[184:185]
  v_pk_add_f32 v[118:119], v[118:119], v[186:187]
  v_pk_add_f32 v[116:117], v[116:117], v[148:149]
  v_pk_add_f32 v[118:119], v[118:119], v[150:151]
  v_cvt_pk_bf16_f32 v200, v116, v117
  v_cvt_pk_bf16_f32 v201, v118, v119
  buffer_store_dwordx2 v[200:201], v1, s[16:19], s36 offen offset:0
  s_waitcnt lgkmcnt(8)
  v_pk_add_f32 v[120:121], v[120:121], v[136:137]
  v_pk_add_f32 v[152:153], v[152:153], v[168:169]
  v_pk_add_f32 v[122:123], v[122:123], v[138:139]
  v_pk_add_f32 v[154:155], v[154:155], v[170:171]
  v_pk_add_f32 v[120:121], v[120:121], v[188:189]
  v_pk_add_f32 v[122:123], v[122:123], v[190:191]
  v_pk_add_f32 v[120:121], v[120:121], v[152:153]
  v_pk_add_f32 v[122:123], v[122:123], v[154:155]
  v_cvt_pk_bf16_f32 v202, v120, v121
  v_cvt_pk_bf16_f32 v203, v122, v123
  buffer_store_dwordx2 v[202:203], v1, s[16:19], s36 offen offset:1024
  s_waitcnt lgkmcnt(4)
  v_pk_add_f32 v[124:125], v[124:125], v[140:141]
  v_pk_add_f32 v[156:157], v[156:157], v[172:173]
  v_pk_add_f32 v[126:127], v[126:127], v[142:143]
  v_pk_add_f32 v[158:159], v[158:159], v[174:175]
  v_pk_add_f32 v[124:125], v[124:125], v[192:193]
  v_pk_add_f32 v[126:127], v[126:127], v[194:195]
  v_pk_add_f32 v[124:125], v[124:125], v[156:157]
  v_pk_add_f32 v[126:127], v[126:127], v[158:159]
  v_cvt_pk_bf16_f32 v204, v124, v125
  v_cvt_pk_bf16_f32 v205, v126, v127
  buffer_store_dwordx2 v[204:205], v1, s[16:19], s36 offen offset:2048
  s_waitcnt lgkmcnt(0)
  v_pk_add_f32 v[128:129], v[128:129], v[144:145]
  v_pk_add_f32 v[160:161], v[160:161], v[176:177]
  v_pk_add_f32 v[130:131], v[130:131], v[146:147]
  v_pk_add_f32 v[162:163], v[162:163], v[178:179]
  v_pk_add_f32 v[128:129], v[128:129], v[196:197]
  v_pk_add_f32 v[130:131], v[130:131], v[198:199]
  v_pk_add_f32 v[128:129], v[128:129], v[160:161]
  v_pk_add_f32 v[130:131], v[130:131], v[162:163]
  v_cvt_pk_bf16_f32 v206, v128, v129
  v_cvt_pk_bf16_f32 v207, v130, v131
  buffer_store_dwordx2 v[206:207], v1, s[16:19], s36 offen offset:3072
  s_endpgm
CODE_END:
.section .rodata,"a"
.p2align 6
.amdhsa_kernel standalone__controlnet__diffusion_kernel
  .amdhsa_next_free_vgpr 256
  .amdhsa_next_free_sgpr 102
  .amdhsa_accum_offset 256
  .amdhsa_group_segment_fixed_size 0
  .amdhsa_kernarg_size 72
  .amdhsa_user_sgpr_count 2
  .amdhsa_user_sgpr_kernarg_segment_ptr 1
  .amdhsa_system_sgpr_workgroup_id_x 1
.end_amdhsa_kernel
```
